```python
import torch

def _softmax(x, axis=-1):
    return torch.softmax(x, dim=axis)
def _gelu(x):
    return torch.nn.functional.gelu(x, approximate="tanh")
def _silu(x):
    return torch.nn.functional.silu(x)
def _sigmoid(x):
    return torch.sigmoid(x)
def _layernorm(x, axis=-1, eps=1e-5):
    m = x.mean(dim=axis, keepdim=True)
    v = x.var(dim=axis, keepdim=True, unbiased=False)
    return (x - m) / torch.sqrt(v + eps)
def _scatter_add(tgt, idx, src, axis=0):
    return tgt.clone().index_add_(axis, idx, src)
def _segment_sum(src, seg, n):
    out = torch.zeros((n,) + src.shape[1:], dtype=src.dtype)
    return out.index_add_(0, seg, src)
def _pad(x, pw):
    flat = tuple(v for pair in reversed(pw) for v in pair)
    return torch.nn.functional.pad(x, flat)

kernel_name = 'gated_mix__ssm_conv_h3__dense_activation_silu__prompt'

def setup_inputs():

    _w = (lambda a: (lambda t: t.to(torch.bfloat16) if t.is_floating_point() else t)(torch.as_tensor(a)))
    def _A_setup():
        B, S, D = 1, 2048, 512
        ks = 4
        return {
            "q": _w((lambda *s: torch.randn(*s, dtype=torch.bfloat16) * 0.05)(B, S, D)),
            "k": _w((lambda *s: torch.randn(*s, dtype=torch.bfloat16) * 0.2)(B, S, D)),
            "v": _w((lambda *s: torch.randn(*s, dtype=torch.bfloat16) * 0.2)(B, S, D)),
            "shift_k": _w((lambda *s: torch.randn(*s, dtype=torch.bfloat16) * 0.2)(D, ks) * 0.5),
            "ssm_k": _w((lambda *s: torch.randn(*s, dtype=torch.bfloat16) * 0.4)(D, S) * (1.0 / S ** 0.5)),
            "ssm_D": _w((lambda *s: torch.randn(*s, dtype=torch.bfloat16) * 0.2)(D)),
        }
    _A_in = _A_setup()

    def _B_setup():
        B, S, D, F = 1, 2048, 512, 1792
        return {
            "x": _w((lambda *s: torch.randn(*s, dtype=torch.bfloat16) * 0.05)(B, S, D)),
            "w1": _w((lambda *s: torch.randn(*s, dtype=torch.bfloat16) * 3.2)(D, F) * (D ** -0.5)),
            "w2": _w((lambda *s: torch.randn(*s, dtype=torch.bfloat16) * 0.05)(F, D) * (F ** -0.5)),
        }
    _B_in = _B_setup()

    return {
        "A_q": _A_in["q"],
        "A_k": _A_in["k"],
        "A_v": _A_in["v"],
        "A_shift_k": _A_in["shift_k"],
        "A_ssm_k": _A_in["ssm_k"],
        "A_ssm_D": _A_in["ssm_D"],
        "B_x": _B_in["x"],
        "B_w1": _B_in["w1"],
        "B_w2": _B_in["w2"],
        "gate_w": _w((lambda *s: torch.randn(*s, dtype=torch.bfloat16) * 0.05)(512) * 16.0),
    }

def reference(A_q, A_k, A_v, A_shift_k, A_ssm_k, A_ssm_D, B_x, B_w1, B_w2, gate_w):
    def _A_ref(q, k, v, shift_k, ssm_k, ssm_D):
        B, S, D = q.shape
        ks = shift_k.shape[-1]
        k_pad = _pad(k, ((0, 0), (ks - 1, 0), (0, 0)))
        k_shift = torch.zeros_like(k)
        for t in range(ks):
            k_shift = k_shift + k_pad[:, t:t + S, :] * shift_k[:, ks - 1 - t][None, None, :]
        kv = k_shift * v
        L = 2 * S
        kv_pad = _pad(kv, ((0, 0), (0, S), (0, 0)))
        kf_pad = _pad(ssm_k, ((0, 0), (0, S)))
        kv_f = (lambda x, axes=(-2,-1): torch.fft.rfft2(x.float(), dim=axes))(kv_pad[:, None, :, :], axes=(1, 2))
        kf_f = (lambda x, axes=(-2,-1): torch.fft.rfft2(x.float(), dim=axes))(kf_pad[:, None, :], axes=(1, 2))
        kf_f = (lambda x, *d: x.permute(*d))(kf_f, 1, 2, 0)
        y_f = kv_f * kf_f[None, :, :, :]
        y = (lambda x, s, axes=(-2,-1): torch.fft.irfft2(x, s=s, dim=axes).to(torch.bfloat16))(y_f, (1, L), axes=(1, 2))[:, 0, :S, :]
        y = y + kv * ssm_D[None, None, :]
        return q * y

    def _B_ref(x, w1, w2):
        h = torch.einsum("bsd,df->bsf", x, w1)
        h = _silu(h)
        out = torch.einsum("bsf,fd->bsd", h, w2)
        return out

    x = A_q
    g = _sigmoid((x * gate_w).sum(-1, keepdims=True))
    a = _A_ref(x, A_k, A_v, A_shift_k, A_ssm_k, A_ssm_D)
    b = _B_ref(x, B_w1, B_w2)
    return g * a + (1 - g) * b
```

```asm
; @launch grid=(256,1,1) block=(256,1,1) lds=163840
.amdgcn_target "amdgcn-amd-amdhsa--gfx950"
.text
.globl gated_mix__ssm_conv_h3__dense_activation_silu__prompt_kernel
.p2align 8
.type gated_mix__ssm_conv_h3__dense_activation_silu__prompt_kernel,@function
gated_mix__ssm_conv_h3__dense_activation_silu__prompt_kernel:
    s_cmp_ge_u32 s2, 256
    s_cbranch_scc1 L_end
    s_load_dwordx2 s[44:45], s[0:1], 0
    s_load_dwordx2 s[48:49], s[0:1], 56
    s_load_dwordx2 s[52:53], s[0:1], 96
    s_load_dwordx2 s[72:73], s[0:1], 8
    s_load_dwordx2 s[76:77], s[0:1], 16
    v_lshrrev_b32 v2, 6, v0
    v_and_b32 v1, 63, v0
    s_and_b32 s4, s2, 7
    s_lshr_b32 s5, s2, 3
    v_readfirstlane_b32 s3, v2
    v_lshlrev_b32 v11, 4, v1
    s_getreg_b32 s28, hwreg(20, 0, 4)
    s_lshl_b32 s22, s3, 12
    s_cmp_ge_u32 s5, 28
    s_cbranch_scc1 L_spare
    s_getpc_b64 s[12:13]
L_pc_1:
    s_lshl_b32 s14, s5, 2
    s_add_u32 s14, s14, s3
    s_lshl_b32 s14, s14, 10
    s_cmp_lt_u32 s14, (L_codeend - L_pc_1 - 1024)
    s_cselect_b32 s14, s14, 0
    v_add_u32 v228, s14, v11
    global_load_dwordx4 v[224:227], v228, s[12:13]
    s_lshl_b32 s6, s4, 1
    s_and_b32 s7, s5, 1
    s_add_u32 s6, s6, s7
    s_lshr_b32 s7, s5, 1
    v_lshrrev_b32 v5, 3, v1
    v_and_b32 v6, 7, v1
    v_lshrrev_b32 v7, 1, v5
    v_xor_b32 v7, v7, v6
    v_xor_b32 v8, 4, v7
    v_lshlrev_b32 v9, 10, v5
    v_lshl_add_u32 v9, v2, 15, v9
    s_lshl_b32 s20, s6, 17
    v_add_u32 v9, s20, v9
    v_lshl_add_u32 v192, v7, 4, v9
    v_lshl_add_u32 v193, v8, 4, v9
    v_add_u32 v194, 14336, v192
    v_add_u32 v195, 21504, v193
    v_add_u32 v193, 7168, v193
    s_lshr_b32 s24, s5, 1
    s_add_u32 s24, s24, s4
    s_mul_i32 s27, s24, 37
    s_lshr_b32 s27, s27, 8
    s_add_u32 s24, s24, s27
    s_add_u32 s24, s24, 4
    s_add_u32 s24, s24, 7
    s_and_b32 s24, s24, 7
    s_lshl_b32 s27, s24, 7
    s_add_u32 s23, s22, 16384
    s_lshl_b32 s21, s7, 8
    s_add_u32 s21, s21, 4096
    v_lshl_add_u32 v5, v2, 4, v5
    v_mul_u32_u24 v5, 3584, v5
    v_and_b32 v6, 1, v1
    v_lshl_add_u32 v5, v6, 4, v5
    v_add_u32 v5, s21, v5
    v_bfe_u32 v6, v1, 1, 2
    v_bfe_u32 v8, v1, 4, 1
    v_xor_b32 v6, v6, v8
    v_xor_b32 v8, 2, v6
    v_lshl_add_u32 v196, v6, 5, v5
    v_lshl_add_u32 v197, v8, 5, v5
    v_subrev_u32 v198, 1920, v196
    v_add_u32 v199, 25728, v197
    v_add_u32 v197, 27648, v197
    s_mov_b32 s46, 2097152
    s_mov_b32 s47, 0x00020000
    s_mov_b32 s50, 1839104
    s_mov_b32 s51, 0x00020000
    s_load_dwordx2 s[80:81], s[0:1], 24
    s_load_dwordx2 s[60:61], s[0:1], 32
    s_load_dwordx2 s[56:57], s[0:1], 88
    s_load_dwordx2 s[84:85], s[0:1], 72
    s_load_dwordx2 s[64:65], s[0:1], 64
    s_load_dwordx2 s[68:69], s[0:1], 80
    s_load_dwordx2 s[40:41], s[0:1], 40
    s_memrealtime s[42:43]
    s_waitcnt lgkmcnt(0)
    s_sub_u32 s48, s48, 4096
    s_subb_u32 s49, s49, 0
    s_add_u32 s27, s27, 128
    s_add_u32 m0, s22, 0
    s_and_b32 s27, s27, 1023
    buffer_load_dwordx4 v192, s[44:47], s27 offen offset:0 lds
    buffer_load_dwordx4 v193, s[44:47], s27 offen offset:1024 lds
    buffer_load_dwordx4 v194, s[44:47], s27 offen offset:2048 lds
    buffer_load_dwordx4 v195, s[44:47], s27 offen offset:3072 lds
    s_add_u32 m0, s23, 0
    s_mul_i32 s29, s27, 1792
    buffer_load_dwordx4 v196, s[48:51], s29 offen offset:0 lds
    buffer_load_dwordx4 v197, s[48:51], s29 offen offset:1024 lds
    buffer_load_dwordx4 v198, s[48:51], s29 offen offset:2048 lds
    buffer_load_dwordx4 v199, s[48:51], s29 offen offset:3072 lds
    s_mov_b32 s58, 256
    s_mov_b32 s59, 0x00020000
    s_mov_b32 s54, 18874368
    s_mov_b32 s55, 0x00020000
    s_or_b32 s24, s5, s3
    s_cmp_lg_u32 s24, 0
    s_cbranch_scc1 L_nn_2
    s_and_b32 s43, s43, 0xffffff
    s_or_b32 s43, s43, 0x40000000
    v_mov_b32 v6, s42
    v_mov_b32 v7, s43
    s_lshl_b32 s24, s4, 3
    v_mov_b32 v5, 0
    s_mov_b64 exec, 1
    buffer_store_dwordx2 v[6:7], v5, s[56:59], s24 offen sc1
    s_mov_b64 exec, -1
L_nn_2:
    v_min_u32 v229, 18, v1
    s_lshl_b32 s92, s5, 2
    s_add_u32 s92, s92, s3
    s_mul_i32 s92, s92, 19456
    s_lshl_b32 s93, s4, 7
    s_add_u32 s92, s92, s93
    v_lshl_add_u32 v229, v229, 10, s92
    s_mov_b32 s74, 2097152
    s_mov_b32 s75, 0x00020000
    s_mov_b32 s78, 2097152
    s_mov_b32 s79, 0x00020000
    buffer_load_dword v230, v229, s[72:75], 0 offen
    buffer_load_dword v231, v229, s[76:79], 0 offen
    v_and_b32 v3, 15, v1
    v_lshrrev_b32 v4, 4, v1
    v_mov_b32 v10, 0
    s_lshl_b32 s8, s4, 2
    s_and_b32 s9, s5, 3
    s_add_u32 s8, s8, s9
    s_lshr_b32 s9, s5, 2
    s_lshl_b32 s10, s4, 5
    s_add_u32 s10, s10, s5
    s_lshr_b32 s32, s3, 1
    s_and_b32 s33, s3, 1
    s_lshl_b32 s34, s10, 1
    s_add_u32 s34, s34, s32
    s_lshl_b32 s35, s34, 12
    s_lshl_b32 s36, s33, 11
    s_add_u32 s37, s35, s36
    s_lshl_b32 s38, s10, 2
    s_load_dword s39, s[40:41], s38
    s_load_dwordx2 s[94:95], s[60:61], s35
    s_add_u32 s38, s35, 2048
    s_load_dwordx2 s[96:97], s[60:61], s38
    v_lshrrev_b32 v5, 1, v3
    v_xor_b32 v5, v5, v4
    v_lshlrev_b32 v5, 4, v5
    v_lshl_add_u32 v5, v3, 7, v5
    s_lshl_b32 s24, s32, 13
    v_add_u32 v200, s24, v5
    v_xor_b32 v203, 64, v200
    v_bfe_u32 v5, v1, 2, 2
    v_lshrrev_b32 v8, 1, v5
    v_and_b32 v9, 1, v4
    v_lshl_add_u32 v8, v9, 1, v8
    v_lshlrev_b32 v5, 7, v5
    v_lshl_add_u32 v5, v9, 10, v5
    v_lshrrev_b32 v9, 1, v4
    v_lshl_add_u32 v5, v9, 12, v5
    v_and_b32 v9, 3, v1
    v_lshl_add_u32 v5, v9, 3, v5
    s_add_u32 s24, s36, 16384
    v_add_u32 v5, s24, v5
    s_and_b32 s24, s5, 1
    s_lshl_b32 s24, s24, 1
    v_xor_b32 v8, s24, v8
    v_xor_b32 v9, 0, v8
    v_lshl_add_u32 v206, v9, 5, v5
    v_xor_b32 v9, 1, v8
    v_lshl_add_u32 v209, v9, 5, v5
    v_xor_b32 v9, 2, v8
    v_lshl_add_u32 v212, v9, 5, v5
    v_xor_b32 v9, 3, v8
    v_lshl_add_u32 v215, v9, 5, v5
    v_add_u32 v201, 0x10000, v200
    v_add_u32 v204, 0x10000, v203
    v_add_u32 v207, 0x10000, v206
    v_add_u32 v210, 0x10000, v209
    v_add_u32 v213, 0x10000, v212
    v_add_u32 v216, 0x10000, v215
    s_mov_b32 s62, 2097152
    s_mov_b32 s63, 0x00020000
    s_mov_b32 s66, 1835008
    s_mov_b32 s67, 0x00020000
    s_mov_b32 s70, 2097152
    s_mov_b32 s71, 0x00020000
    s_lshl_b32 s92, s10, 2
    s_add_u32 s92, s92, s3
    s_lshl_b32 s92, s92, 11
    v_lshl_add_u32 v80, v3, 7, s92
    v_and_b32 v14, 7, v1
    v_lshlrev_b32 v14, 3, v14
    v_lshrrev_b32 v5, 3, v1
    v_bfe_u32 v6, v1, 1, 2
    v_and_b32 v7, 1, v1
    v_bfe_u32 v8, v5, 1, 1
    v_xor_b32 v6, v6, v8
    v_xor_b32 v8, 2, v6
    v_and_b32 v9, 3, v5
    v_lshrrev_b32 v5, 2, v5
    v_lshl_add_u32 v9, v5, 4, v9
    v_lshlrev_b32 v9, 10, v9
    v_lshl_add_u32 v9, v7, 4, v9
    s_lshl_b32 s25, s9, 7
    s_mul_i32 s24, s3, 458752
    s_add_u32 s25, s25, s24
    v_add_u32 v9, s25, v9
    v_lshl_add_u32 v240, v6, 5, v9
    v_lshl_add_u32 v241, v8, 5, v9
    v_add_u32 v242, 6144, v240
    v_add_u32 v243, 9216, v241
    v_add_u32 v241, 3072, v241
    s_bfe_u32 s79, s5, 0x10001
    s_lshl_b32 s80, s79, 15
    s_xor_b32 s81, s80, 32768
    s_mul_i32 s82, s79, 28672
    s_mul_i32 s83, s79, -57344
    s_add_u32 s83, s83, 28672
    s_add_u32 s24, s4, s9
    s_sub_u32 s25, s24, 7
    s_cselect_b32 s24, s24, s25
    s_sub_u32 s25, s24, 7
    s_cselect_b32 s24, s24, s25
    s_lshl_b32 s72, s24, 10
    s_add_u32 s73, s72, 1024
    s_cmp_eq_u32 s73, 7168
    s_cselect_b32 s73, 0, s73
    s_add_u32 s74, s73, 1024
    s_cmp_eq_u32 s74, 7168
    s_cselect_b32 s74, 0, s74
    s_add_u32 s75, s74, 1024
    s_cmp_eq_u32 s75, 7168
    s_cselect_b32 s75, 0, s75
    s_add_u32 s76, s75, 1024
    s_cmp_eq_u32 s76, 7168
    s_cselect_b32 s76, 0, s76
    s_add_u32 s77, s76, 1024
    s_cmp_eq_u32 s77, 7168
    s_cselect_b32 s77, 0, s77
    s_add_u32 s78, s77, 1024
    s_cmp_eq_u32 s78, 7168
    s_cselect_b32 s78, 0, s78
    s_lshl_b32 s84, s76, 6
    s_or_b32 s84, s84, s81
    s_lshl_b32 s85, s77, 6
    s_or_b32 s85, s85, s81
    s_lshl_b32 s86, s78, 6
    s_or_b32 s86, s86, s81
    s_mov_b32 s16, 0xbfb8aa3b
    s_mov_b32 s17, 0xbfb8aa3b
    s_lshl_b32 s12, s6, 3
    s_lshl_b32 s13, s32, 2
    s_add_u32 s12, s12, s13
    s_mul_i32 s12, s12, 57344
    s_lshl_b32 s11, s7, 1
    s_add_u32 s11, s11, s33
    s_lshl_b32 s13, s11, 10
    s_add_u32 s12, s12, s13
    s_add_u32 s12, s12, 2097152
    s_add_u32 s13, s12, 57344
    s_add_u32 s14, s13, 57344
    s_add_u32 s15, s14, 57344
    s_and_b32 s24, s5, 1
    s_mul_i32 s24, s24, 28672
    v_add_u32 v219, s24, v11
    s_sub_u32 s24, 28672, s24
    v_add_u32 v15, s24, v11
    s_mul_i32 s24, s11, 37
    s_lshr_b32 s24, s24, 8
    s_add_u32 s24, s24, s11
    s_lshl_b32 s24, s24, 3
    s_lshl_b32 s11, s6, 1
    s_add_u32 s11, s11, s32
    s_lshl_b32 s11, s11, 9
    s_add_u32 s11, s11, s24
    s_add_u32 s11, s11, 12656640
    v_bfe_u32 v5, v1, 2, 2
    v_lshrrev_b32 v6, 1, v5
    v_and_b32 v7, 1, v4
    v_lshl_add_u32 v6, v7, 1, v6
    v_lshl_add_u32 v5, v4, 3, v5
    v_lshlrev_b32 v5, 7, v5
    v_and_b32 v7, 3, v1
    v_lshl_add_u32 v5, v7, 3, v5
    v_add_u32 v5, s22, v5
    v_xor_b32 v7, 0, v6
    v_lshl_add_u32 v232, v7, 5, v5
    v_add_u32 v236, 0x10000, v232
    v_xor_b32 v7, 1, v6
    v_lshl_add_u32 v233, v7, 5, v5
    v_add_u32 v237, 0x10000, v233
    v_xor_b32 v7, 2, v6
    v_lshl_add_u32 v234, v7, 5, v5
    v_add_u32 v238, 0x10000, v234
    v_xor_b32 v7, 3, v6
    v_lshl_add_u32 v235, v7, 5, v5
    v_add_u32 v239, 0x10000, v235
    s_mul_i32 s18, s32, 16640
    s_add_u32 s18, s18, 130560
    s_mul_i32 s20, s32, 4608
    s_add_u32 s20, s20, 121344
    v_add_u32 v5, 1, v3
    v_and_b32 v6, 3, v5
    v_sub_u32 v5, v5, v6
    v_mul_u32_u24 v6, 4160, v6
    v_lshl_add_u32 v250, v5, 1, v6
    v_lshl_add_u32 v250, v4, 4, v250
    s_lshl_b32 s38, s33, 8
    s_add_u32 s24, s18, s38
    v_add_u32 v250, s24, v250
    v_lshlrev_b32 v5, 5, v3
    v_lshlrev_b32 v6, 4, v4
    v_sub_u32 v251, v6, v5
    s_add_u32 s24, s20, s38
    s_add_u32 s24, s24, 480
    v_add_u32 v251, s24, v251
    s_mul_i32 s24, s3, 7168
    s_add_u32 s24, s24, 2097152
    s_lshl_b32 s34, s8, 2
    s_add_u32 s25, s3, 0
    s_and_b32 s25, s25, 3
    s_add_u32 s25, s25, s34
    s_mul_i32 s25, s25, 57344
    s_add_u32 s25, s25, s24
    v_add_u32 v244, s25, v11
    s_add_u32 s25, s3, 1
    s_and_b32 s25, s25, 3
    s_add_u32 s25, s25, s34
    s_mul_i32 s25, s25, 57344
    s_add_u32 s25, s25, s24
    v_add_u32 v245, s25, v11
    s_add_u32 s25, s3, 2
    s_and_b32 s25, s25, 3
    s_add_u32 s25, s25, s34
    s_mul_i32 s25, s25, 57344
    s_add_u32 s25, s25, s24
    v_add_u32 v246, s25, v11
    s_add_u32 s25, s3, 3
    s_and_b32 s25, s25, 3
    s_add_u32 s25, s25, s34
    s_mul_i32 s25, s25, 57344
    s_add_u32 s25, s25, s24
    v_add_u32 v247, s25, v11
    s_add_u32 s27, s27, 128
    s_add_u32 m0, s22, 32768
    s_and_b32 s27, s27, 1023
    buffer_load_dwordx4 v192, s[44:47], s27 offen offset:0 lds
    buffer_load_dwordx4 v193, s[44:47], s27 offen offset:1024 lds
    buffer_load_dwordx4 v194, s[44:47], s27 offen offset:2048 lds
    buffer_load_dwordx4 v195, s[44:47], s27 offen offset:3072 lds
    s_add_u32 m0, s23, 32768
    s_mul_i32 s29, s27, 1792
    buffer_load_dwordx4 v196, s[48:51], s29 offen offset:0 lds
    buffer_load_dwordx4 v197, s[48:51], s29 offen offset:1024 lds
    buffer_load_dwordx4 v198, s[48:51], s29 offen offset:2048 lds
    buffer_load_dwordx4 v199, s[48:51], s29 offen offset:3072 lds
    s_waitcnt vmcnt(10)
    s_waitcnt lgkmcnt(0)
    s_barrier
    ds_read_b64_tr_b16 a[160:161], v206 offset:0
    ds_read_b64_tr_b16 a[162:163], v206 offset:512
    ds_read_b128 a[128:131], v200 offset:0
    ds_read_b128 a[132:135], v200 offset:2048
    ds_read_b128 a[136:139], v200 offset:4096
    ds_read_b128 a[140:143], v200 offset:6144
    ds_read_b64_tr_b16 a[164:165], v209 offset:0
    ds_read_b64_tr_b16 a[166:167], v209 offset:512
    ds_read_b64_tr_b16 a[168:169], v212 offset:0
    ds_read_b64_tr_b16 a[170:171], v212 offset:512
    ds_read_b64_tr_b16 a[172:173], v215 offset:0
    ds_read_b64_tr_b16 a[174:175], v215 offset:512
    s_waitcnt lgkmcnt(4)
    v_mfma_f32_16x16x32_bf16 v[16:19], a[160:163], a[128:131], 0
    ds_read_b64_tr_b16 a[176:177], v206 offset:8192
    v_mfma_f32_16x16x32_bf16 v[32:35], a[160:163], a[132:135], 0
    ds_read_b64_tr_b16 a[178:179], v206 offset:8704
    v_mfma_f32_16x16x32_bf16 v[48:51], a[160:163], a[136:139], 0
    ds_read_b128 a[144:147], v203 offset:0
    v_mfma_f32_16x16x32_bf16 v[64:67], a[160:163], a[140:143], 0
    ds_read_b128 a[148:151], v203 offset:2048
    v_mfma_f32_16x16x32_bf16 v[20:23], a[164:167], a[128:131], 0
    ds_read_b128 a[152:155], v203 offset:4096
    v_mfma_f32_16x16x32_bf16 v[36:39], a[164:167], a[132:135], 0
    ds_read_b128 a[156:159], v203 offset:6144
    v_mfma_f32_16x16x32_bf16 v[52:55], a[164:167], a[136:139], 0
    ds_read_b64_tr_b16 a[180:181], v209 offset:8192
    v_mfma_f32_16x16x32_bf16 v[68:71], a[164:167], a[140:143], 0
    ds_read_b64_tr_b16 a[182:183], v209 offset:8704
    s_waitcnt lgkmcnt(8)
    v_mfma_f32_16x16x32_bf16 v[24:27], a[168:171], a[128:131], 0
    ds_read_b64_tr_b16 a[184:185], v212 offset:8192
    v_mfma_f32_16x16x32_bf16 v[40:43], a[168:171], a[132:135], 0
    ds_read_b64_tr_b16 a[186:187], v212 offset:8704
    v_mfma_f32_16x16x32_bf16 v[56:59], a[168:171], a[136:139], 0
    ds_read_b64_tr_b16 a[188:189], v215 offset:8192
    v_mfma_f32_16x16x32_bf16 v[72:75], a[168:171], a[140:143], 0
    ds_read_b64_tr_b16 a[190:191], v215 offset:8704
    v_mfma_f32_16x16x32_bf16 v[28:31], a[172:175], a[128:131], 0
    s_add_u32 s27, s27, 128
    s_add_u32 m0, s22, 65536
    s_and_b32 s27, s27, 1023
    buffer_load_dwordx4 v192, s[44:47], s27 offen offset:0 lds
    v_mfma_f32_16x16x32_bf16 v[44:47], a[172:175], a[132:135], 0
    v_mfma_f32_16x16x32_bf16 v[60:63], a[172:175], a[136:139], 0
    buffer_load_dwordx4 v193, s[44:47], s27 offen offset:1024 lds
    v_mfma_f32_16x16x32_bf16 v[76:79], a[172:175], a[140:143], 0
    buffer_load_dwordx4 v194, s[44:47], s27 offen offset:2048 lds
    buffer_load_dwordx4 v195, s[44:47], s27 offen offset:3072 lds
    s_add_u32 m0, s23, 65536
    s_mul_i32 s29, s27, 1792
    buffer_load_dwordx4 v196, s[48:51], s29 offen offset:0 lds
    buffer_load_dwordx4 v197, s[48:51], s29 offen offset:1024 lds
    buffer_load_dwordx4 v198, s[48:51], s29 offen offset:2048 lds
    buffer_load_dwordx4 v199, s[48:51], s29 offen offset:3072 lds
    buffer_load_dwordx2 v[248:249], v14, s[56:59], 0 offen sc1
    s_add_u32 s27, s27, 128
    s_add_u32 m0, s22, 98304
    s_and_b32 s27, s27, 1023
    buffer_load_dwordx4 v192, s[44:47], s27 offen offset:0 lds
    s_waitcnt vmcnt(10) lgkmcnt(0)
    s_barrier
    v_mfma_f32_16x16x32_bf16 v[16:19], a[176:179], a[144:147], v[16:19]
    ds_read_b64_tr_b16 a[160:161], v206 offset:32768
    buffer_load_dwordx4 v193, s[44:47], s27 offen offset:1024 lds
    v_mfma_f32_16x16x32_bf16 v[32:35], a[176:179], a[148:151], v[32:35]
    ds_read_b64_tr_b16 a[162:163], v206 offset:33280
    v_mfma_f32_16x16x32_bf16 v[48:51], a[176:179], a[152:155], v[48:51]
    ds_read_b128 a[128:131], v200 offset:32768
    v_mfma_f32_16x16x32_bf16 v[64:67], a[176:179], a[156:159], v[64:67]
    ds_read_b128 a[132:135], v200 offset:34816
    v_mfma_f32_16x16x32_bf16 v[20:23], a[180:183], a[144:147], v[20:23]
    ds_read_b128 a[136:139], v200 offset:36864
    v_mfma_f32_16x16x32_bf16 v[36:39], a[180:183], a[148:151], v[36:39]
    ds_read_b128 a[140:143], v200 offset:38912
    v_mfma_f32_16x16x32_bf16 v[52:55], a[180:183], a[152:155], v[52:55]
    ds_read_b64_tr_b16 a[164:165], v209 offset:32768
    v_mfma_f32_16x16x32_bf16 v[68:71], a[180:183], a[156:159], v[68:71]
    ds_read_b64_tr_b16 a[166:167], v209 offset:33280
    v_mfma_f32_16x16x32_bf16 v[24:27], a[184:187], a[144:147], v[24:27]
    ds_read_b64_tr_b16 a[168:169], v212 offset:32768
    v_mfma_f32_16x16x32_bf16 v[40:43], a[184:187], a[148:151], v[40:43]
    ds_read_b64_tr_b16 a[170:171], v212 offset:33280
    v_mfma_f32_16x16x32_bf16 v[56:59], a[184:187], a[152:155], v[56:59]
    ds_read_b64_tr_b16 a[172:173], v215 offset:32768
    v_mfma_f32_16x16x32_bf16 v[72:75], a[184:187], a[156:159], v[72:75]
    ds_read_b64_tr_b16 a[174:175], v215 offset:33280
    buffer_load_dwordx4 v194, s[44:47], s27 offen offset:2048 lds
    v_mfma_f32_16x16x32_bf16 v[28:31], a[188:191], a[144:147], v[28:31]
    v_mfma_f32_16x16x32_bf16 v[44:47], a[188:191], a[148:151], v[44:47]
    v_mfma_f32_16x16x32_bf16 v[60:63], a[188:191], a[152:155], v[60:63]
    v_mfma_f32_16x16x32_bf16 v[76:79], a[188:191], a[156:159], v[76:79]
    s_waitcnt lgkmcnt(4)
    v_mfma_f32_16x16x32_bf16 v[16:19], a[160:163], a[128:131], v[16:19]
    ds_read_b64_tr_b16 a[176:177], v206 offset:40960
    v_mfma_f32_16x16x32_bf16 v[32:35], a[160:163], a[132:135], v[32:35]
    ds_read_b64_tr_b16 a[178:179], v206 offset:41472
    buffer_load_dwordx4 v195, s[44:47], s27 offen offset:3072 lds
    v_mfma_f32_16x16x32_bf16 v[48:51], a[160:163], a[136:139], v[48:51]
    ds_read_b128 a[144:147], v203 offset:32768
    v_mfma_f32_16x16x32_bf16 v[64:67], a[160:163], a[140:143], v[64:67]
    ds_read_b128 a[148:151], v203 offset:34816
    v_mfma_f32_16x16x32_bf16 v[20:23], a[164:167], a[128:131], v[20:23]
    ds_read_b128 a[152:155], v203 offset:36864
    v_mfma_f32_16x16x32_bf16 v[36:39], a[164:167], a[132:135], v[36:39]
    ds_read_b128 a[156:159], v203 offset:38912
    v_mfma_f32_16x16x32_bf16 v[52:55], a[164:167], a[136:139], v[52:55]
    ds_read_b64_tr_b16 a[180:181], v209 offset:40960
    v_mfma_f32_16x16x32_bf16 v[68:71], a[164:167], a[140:143], v[68:71]
    ds_read_b64_tr_b16 a[182:183], v209 offset:41472
    s_waitcnt lgkmcnt(8)
    v_mfma_f32_16x16x32_bf16 v[24:27], a[168:171], a[128:131], v[24:27]
    ds_read_b64_tr_b16 a[184:185], v212 offset:40960
    v_mfma_f32_16x16x32_bf16 v[40:43], a[168:171], a[132:135], v[40:43]
    ds_read_b64_tr_b16 a[186:187], v212 offset:41472
    v_mfma_f32_16x16x32_bf16 v[56:59], a[168:171], a[136:139], v[56:59]
    ds_read_b64_tr_b16 a[188:189], v215 offset:40960
    v_mfma_f32_16x16x32_bf16 v[72:75], a[168:171], a[140:143], v[72:75]
    ds_read_b64_tr_b16 a[190:191], v215 offset:41472
    v_mfma_f32_16x16x32_bf16 v[28:31], a[172:175], a[128:131], v[28:31]
    s_add_u32 m0, s23, 98304
    s_mul_i32 s29, s27, 1792
    buffer_load_dwordx4 v196, s[48:51], s29 offen offset:0 lds
    v_mfma_f32_16x16x32_bf16 v[44:47], a[172:175], a[132:135], v[44:47]
    v_mfma_f32_16x16x32_bf16 v[60:63], a[172:175], a[136:139], v[60:63]
    buffer_load_dwordx4 v197, s[48:51], s29 offen offset:1024 lds
    v_mfma_f32_16x16x32_bf16 v[76:79], a[172:175], a[140:143], v[76:79]
    buffer_load_dwordx4 v198, s[48:51], s29 offen offset:2048 lds
    buffer_load_dwordx4 v199, s[48:51], s29 offen offset:3072 lds
    s_add_u32 s27, s27, 128
    s_add_u32 m0, s22, 0
    s_and_b32 s27, s27, 1023
    buffer_load_dwordx4 v192, s[44:47], s27 offen offset:0 lds
    s_waitcnt vmcnt(10) lgkmcnt(0)
    s_barrier
    v_mfma_f32_16x16x32_bf16 v[16:19], a[176:179], a[144:147], v[16:19]
    ds_read_b64_tr_b16 a[160:161], v207 offset:0
    buffer_load_dwordx4 v193, s[44:47], s27 offen offset:1024 lds
    v_mfma_f32_16x16x32_bf16 v[32:35], a[176:179], a[148:151], v[32:35]
    ds_read_b64_tr_b16 a[162:163], v207 offset:512
    v_mfma_f32_16x16x32_bf16 v[48:51], a[176:179], a[152:155], v[48:51]
    ds_read_b128 a[128:131], v201 offset:0
    v_mfma_f32_16x16x32_bf16 v[64:67], a[176:179], a[156:159], v[64:67]
    ds_read_b128 a[132:135], v201 offset:2048
    v_mfma_f32_16x16x32_bf16 v[20:23], a[180:183], a[144:147], v[20:23]
    ds_read_b128 a[136:139], v201 offset:4096
    buffer_load_dwordx4 v194, s[44:47], s27 offen offset:2048 lds
    v_mfma_f32_16x16x32_bf16 v[36:39], a[180:183], a[148:151], v[36:39]
    ds_read_b128 a[140:143], v201 offset:6144
    v_mfma_f32_16x16x32_bf16 v[52:55], a[180:183], a[152:155], v[52:55]
    ds_read_b64_tr_b16 a[164:165], v210 offset:0
    v_mfma_f32_16x16x32_bf16 v[68:71], a[180:183], a[156:159], v[68:71]
    ds_read_b64_tr_b16 a[166:167], v210 offset:512
    v_mfma_f32_16x16x32_bf16 v[24:27], a[184:187], a[144:147], v[24:27]
    ds_read_b64_tr_b16 a[168:169], v213 offset:0
    v_mfma_f32_16x16x32_bf16 v[40:43], a[184:187], a[148:151], v[40:43]
    ds_read_b64_tr_b16 a[170:171], v213 offset:512
    buffer_load_dwordx4 v195, s[44:47], s27 offen offset:3072 lds
    v_mfma_f32_16x16x32_bf16 v[56:59], a[184:187], a[152:155], v[56:59]
    ds_read_b64_tr_b16 a[172:173], v216 offset:0
    v_mfma_f32_16x16x32_bf16 v[72:75], a[184:187], a[156:159], v[72:75]
    ds_read_b64_tr_b16 a[174:175], v216 offset:512
    v_mfma_f32_16x16x32_bf16 v[28:31], a[188:191], a[144:147], v[28:31]
    v_mfma_f32_16x16x32_bf16 v[44:47], a[188:191], a[148:151], v[44:47]
    v_mfma_f32_16x16x32_bf16 v[60:63], a[188:191], a[152:155], v[60:63]
    v_mfma_f32_16x16x32_bf16 v[76:79], a[188:191], a[156:159], v[76:79]
    s_waitcnt lgkmcnt(4)
    v_mfma_f32_16x16x32_bf16 v[16:19], a[160:163], a[128:131], v[16:19]
    ds_read_b64_tr_b16 a[176:177], v207 offset:8192
    v_mfma_f32_16x16x32_bf16 v[32:35], a[160:163], a[132:135], v[32:35]
    ds_read_b64_tr_b16 a[178:179], v207 offset:8704
    v_mfma_f32_16x16x32_bf16 v[48:51], a[160:163], a[136:139], v[48:51]
    ds_read_b128 a[144:147], v204 offset:0
    v_mfma_f32_16x16x32_bf16 v[64:67], a[160:163], a[140:143], v[64:67]
    ds_read_b128 a[148:151], v204 offset:2048
    v_mfma_f32_16x16x32_bf16 v[20:23], a[164:167], a[128:131], v[20:23]
    ds_read_b128 a[152:155], v204 offset:4096
    v_mfma_f32_16x16x32_bf16 v[36:39], a[164:167], a[132:135], v[36:39]
    ds_read_b128 a[156:159], v204 offset:6144
    v_mfma_f32_16x16x32_bf16 v[52:55], a[164:167], a[136:139], v[52:55]
    ds_read_b64_tr_b16 a[180:181], v210 offset:8192
    v_mfma_f32_16x16x32_bf16 v[68:71], a[164:167], a[140:143], v[68:71]
    ds_read_b64_tr_b16 a[182:183], v210 offset:8704
    s_waitcnt lgkmcnt(8)
    v_mfma_f32_16x16x32_bf16 v[24:27], a[168:171], a[128:131], v[24:27]
    ds_read_b64_tr_b16 a[184:185], v213 offset:8192
    v_mfma_f32_16x16x32_bf16 v[40:43], a[168:171], a[132:135], v[40:43]
    ds_read_b64_tr_b16 a[186:187], v213 offset:8704
    v_mfma_f32_16x16x32_bf16 v[56:59], a[168:171], a[136:139], v[56:59]
    ds_read_b64_tr_b16 a[188:189], v216 offset:8192
    v_mfma_f32_16x16x32_bf16 v[72:75], a[168:171], a[140:143], v[72:75]
    ds_read_b64_tr_b16 a[190:191], v216 offset:8704
    v_mfma_f32_16x16x32_bf16 v[28:31], a[172:175], a[128:131], v[28:31]
    s_add_u32 m0, s23, 0
    s_mul_i32 s29, s27, 1792
    buffer_load_dwordx4 v196, s[48:51], s29 offen offset:0 lds
    v_mfma_f32_16x16x32_bf16 v[44:47], a[172:175], a[132:135], v[44:47]
    v_mfma_f32_16x16x32_bf16 v[60:63], a[172:175], a[136:139], v[60:63]
    v_mfma_f32_16x16x32_bf16 v[76:79], a[172:175], a[140:143], v[76:79]
    buffer_load_dwordx4 v197, s[48:51], s29 offen offset:1024 lds
    buffer_load_dwordx4 v198, s[48:51], s29 offen offset:2048 lds
    buffer_load_dwordx4 v199, s[48:51], s29 offen offset:3072 lds
    s_add_u32 s27, s27, 128
    s_add_u32 m0, s22, 32768
    s_and_b32 s27, s27, 1023
    buffer_load_dwordx4 v192, s[44:47], s27 offen offset:0 lds
    buffer_load_dwordx4 v193, s[44:47], s27 offen offset:1024 lds
    s_waitcnt vmcnt(10) lgkmcnt(0)
    s_barrier
    v_mfma_f32_16x16x32_bf16 v[16:19], a[176:179], a[144:147], v[16:19]
    ds_read_b64_tr_b16 a[160:161], v207 offset:32768
    buffer_load_dwordx4 v194, s[44:47], s27 offen offset:2048 lds
    v_mfma_f32_16x16x32_bf16 v[32:35], a[176:179], a[148:151], v[32:35]
    ds_read_b64_tr_b16 a[162:163], v207 offset:33280
    v_mfma_f32_16x16x32_bf16 v[48:51], a[176:179], a[152:155], v[48:51]
    ds_read_b128 a[128:131], v201 offset:32768
    v_mfma_f32_16x16x32_bf16 v[64:67], a[176:179], a[156:159], v[64:67]
    ds_read_b128 a[132:135], v201 offset:34816
    v_mfma_f32_16x16x32_bf16 v[20:23], a[180:183], a[144:147], v[20:23]
    ds_read_b128 a[136:139], v201 offset:36864
    v_mfma_f32_16x16x32_bf16 v[36:39], a[180:183], a[148:151], v[36:39]
    ds_read_b128 a[140:143], v201 offset:38912
    buffer_load_dwordx4 v195, s[44:47], s27 offen offset:3072 lds
    v_mfma_f32_16x16x32_bf16 v[52:55], a[180:183], a[152:155], v[52:55]
    ds_read_b64_tr_b16 a[164:165], v210 offset:32768
    v_mfma_f32_16x16x32_bf16 v[68:71], a[180:183], a[156:159], v[68:71]
    ds_read_b64_tr_b16 a[166:167], v210 offset:33280
    v_mfma_f32_16x16x32_bf16 v[24:27], a[184:187], a[144:147], v[24:27]
    ds_read_b64_tr_b16 a[168:169], v213 offset:32768
    v_mfma_f32_16x16x32_bf16 v[40:43], a[184:187], a[148:151], v[40:43]
    ds_read_b64_tr_b16 a[170:171], v213 offset:33280
    v_mfma_f32_16x16x32_bf16 v[56:59], a[184:187], a[152:155], v[56:59]
    ds_read_b64_tr_b16 a[172:173], v216 offset:32768
    v_mfma_f32_16x16x32_bf16 v[72:75], a[184:187], a[156:159], v[72:75]
    ds_read_b64_tr_b16 a[174:175], v216 offset:33280
    v_mfma_f32_16x16x32_bf16 v[28:31], a[188:191], a[144:147], v[28:31]
    s_add_u32 m0, s23, 32768
    s_mul_i32 s29, s27, 1792
    buffer_load_dwordx4 v196, s[48:51], s29 offen offset:0 lds
    v_mfma_f32_16x16x32_bf16 v[44:47], a[188:191], a[148:151], v[44:47]
    v_readlane_b32 s89, v249, s4
    v_readlane_b32 s43, v249, s9
    s_min_u32 s92, s89, s43
    s_cmp_eq_u32 s92, 0
    s_cbranch_scc1 L_np_3
L_nd_4:
    v_readlane_b32 s88, v248, s4
    v_readlane_b32 s42, v248, s9
    v_mfma_f32_16x16x32_bf16 v[60:63], a[188:191], a[152:155], v[60:63]
    s_lshl_b32 s91, s28, 24
    s_or_b32 s91, s91, s89
    s_mov_b32 s90, s88
    v_mov_b32 v12, s88
    v_mov_b32 v13, s91
    s_cmp_lg_u32 s3, 0
    s_cbranch_scc1 L_hp_5
    s_lshl_b32 s92, s4, 9
    s_lshl_b32 s93, s5, 3
    s_add_u32 s92, s92, s93
    s_add_u32 s92, s92, 12648448
    s_mov_b64 exec, 1
    buffer_store_dwordx2 v[12:13], v10, s[52:55], s92 offen
    s_mov_b64 exec, -1
L_hp_5:
    v_mfma_f32_16x16x32_bf16 v[76:79], a[188:191], a[156:159], v[76:79]
    s_waitcnt lgkmcnt(4)
    v_mfma_f32_16x16x32_bf16 v[16:19], a[160:163], a[128:131], v[16:19]
    ds_read_b64_tr_b16 a[176:177], v207 offset:40960
    v_mfma_f32_16x16x32_bf16 v[32:35], a[160:163], a[132:135], v[32:35]
    ds_read_b64_tr_b16 a[178:179], v207 offset:41472
    v_mfma_f32_16x16x32_bf16 v[48:51], a[160:163], a[136:139], v[48:51]
    ds_read_b128 a[144:147], v204 offset:32768
    v_mfma_f32_16x16x32_bf16 v[64:67], a[160:163], a[140:143], v[64:67]
    ds_read_b128 a[148:151], v204 offset:34816
    v_mfma_f32_16x16x32_bf16 v[20:23], a[164:167], a[128:131], v[20:23]
    ds_read_b128 a[152:155], v204 offset:36864
    buffer_load_dwordx4 v197, s[48:51], s29 offen offset:1024 lds
    v_mfma_f32_16x16x32_bf16 v[36:39], a[164:167], a[132:135], v[36:39]
    ds_read_b128 a[156:159], v204 offset:38912
    v_mfma_f32_16x16x32_bf16 v[52:55], a[164:167], a[136:139], v[52:55]
    ds_read_b64_tr_b16 a[180:181], v210 offset:40960
    v_mfma_f32_16x16x32_bf16 v[68:71], a[164:167], a[140:143], v[68:71]
    ds_read_b64_tr_b16 a[182:183], v210 offset:41472
    s_waitcnt lgkmcnt(8)
    v_mfma_f32_16x16x32_bf16 v[24:27], a[168:171], a[128:131], v[24:27]
    ds_read_b64_tr_b16 a[184:185], v213 offset:40960
    v_mfma_f32_16x16x32_bf16 v[40:43], a[168:171], a[132:135], v[40:43]
    ds_read_b64_tr_b16 a[186:187], v213 offset:41472
    v_mfma_f32_16x16x32_bf16 v[56:59], a[168:171], a[136:139], v[56:59]
    ds_read_b64_tr_b16 a[188:189], v216 offset:40960
    buffer_load_dwordx4 v198, s[48:51], s29 offen offset:2048 lds
    v_mfma_f32_16x16x32_bf16 v[72:75], a[168:171], a[140:143], v[72:75]
    ds_read_b64_tr_b16 a[190:191], v216 offset:41472
    v_mfma_f32_16x16x32_bf16 v[28:31], a[172:175], a[128:131], v[28:31]
    v_mfma_f32_16x16x32_bf16 v[44:47], a[172:175], a[132:135], v[44:47]
    v_mfma_f32_16x16x32_bf16 v[60:63], a[172:175], a[136:139], v[60:63]
    v_mfma_f32_16x16x32_bf16 v[76:79], a[172:175], a[140:143], v[76:79]
    buffer_load_dwordx4 v199, s[48:51], s29 offen offset:3072 lds
    buffer_load_dwordx4 v[144:147], v11, s[60:63], s37 offen
    s_waitcnt vmcnt(9) lgkmcnt(0)
    s_barrier
    v_mfma_f32_16x16x32_bf16 v[16:19], a[176:179], a[144:147], v[16:19]
    ds_read_b64_tr_b16 a[160:161], v206 offset:0
    buffer_load_dwordx4 v[150:153], v11, s[60:63], s37 offen offset:1024
    v_mfma_f32_16x16x32_bf16 v[32:35], a[176:179], a[148:151], v[32:35]
    ds_read_b64_tr_b16 a[162:163], v206 offset:512
    v_mfma_f32_16x16x32_bf16 v[48:51], a[176:179], a[152:155], v[48:51]
    ds_read_b128 a[128:131], v200 offset:0
    v_mfma_f32_16x16x32_bf16 v[64:67], a[176:179], a[156:159], v[64:67]
    ds_read_b128 a[132:135], v200 offset:2048
    v_mfma_f32_16x16x32_bf16 v[20:23], a[180:183], a[144:147], v[20:23]
    ds_read_b128 a[136:139], v200 offset:4096
    v_mfma_f32_16x16x32_bf16 v[36:39], a[180:183], a[148:151], v[36:39]
    ds_read_b128 a[140:143], v200 offset:6144
    v_mfma_f32_16x16x32_bf16 v[52:55], a[180:183], a[152:155], v[52:55]
    ds_read_b64_tr_b16 a[164:165], v209 offset:0
    v_mfma_f32_16x16x32_bf16 v[68:71], a[180:183], a[156:159], v[68:71]
    ds_read_b64_tr_b16 a[166:167], v209 offset:512
    v_mfma_f32_16x16x32_bf16 v[24:27], a[184:187], a[144:147], v[24:27]
    ds_read_b64_tr_b16 a[168:169], v212 offset:0
    v_mfma_f32_16x16x32_bf16 v[40:43], a[184:187], a[148:151], v[40:43]
    ds_read_b64_tr_b16 a[170:171], v212 offset:512
    v_mfma_f32_16x16x32_bf16 v[56:59], a[184:187], a[152:155], v[56:59]
    ds_read_b64_tr_b16 a[172:173], v215 offset:0
    v_mfma_f32_16x16x32_bf16 v[72:75], a[184:187], a[156:159], v[72:75]
    ds_read_b64_tr_b16 a[174:175], v215 offset:512
    v_mfma_f32_16x16x32_bf16 v[28:31], a[188:191], a[144:147], v[28:31]
    s_add_u32 s27, s27, 128
    s_add_u32 m0, s22, 65536
    s_and_b32 s27, s27, 1023
    buffer_load_dwordx4 v192, s[44:47], s27 offen offset:0 lds
    v_mfma_f32_16x16x32_bf16 v[44:47], a[188:191], a[148:151], v[44:47]
    v_mfma_f32_16x16x32_bf16 v[60:63], a[188:191], a[152:155], v[60:63]
    buffer_load_dwordx4 v193, s[44:47], s27 offen offset:1024 lds
    v_mfma_f32_16x16x32_bf16 v[76:79], a[188:191], a[156:159], v[76:79]
    s_waitcnt lgkmcnt(4)
    v_mfma_f32_16x16x32_bf16 v[16:19], a[160:163], a[128:131], v[16:19]
    ds_read_b64_tr_b16 a[176:177], v206 offset:8192
    v_mfma_f32_16x16x32_bf16 v[32:35], a[160:163], a[132:135], v[32:35]
    ds_read_b64_tr_b16 a[178:179], v206 offset:8704
    buffer_load_dwordx4 v194, s[44:47], s27 offen offset:2048 lds
    v_mfma_f32_16x16x32_bf16 v[48:51], a[160:163], a[136:139], v[48:51]
    ds_read_b128 a[144:147], v203 offset:0
    v_mfma_f32_16x16x32_bf16 v[64:67], a[160:163], a[140:143], v[64:67]
    ds_read_b128 a[148:151], v203 offset:2048
    v_mfma_f32_16x16x32_bf16 v[20:23], a[164:167], a[128:131], v[20:23]
    ds_read_b128 a[152:155], v203 offset:4096
    v_mfma_f32_16x16x32_bf16 v[36:39], a[164:167], a[132:135], v[36:39]
    ds_read_b128 a[156:159], v203 offset:6144
    v_mfma_f32_16x16x32_bf16 v[52:55], a[164:167], a[136:139], v[52:55]
    ds_read_b64_tr_b16 a[180:181], v209 offset:8192
    v_mfma_f32_16x16x32_bf16 v[68:71], a[164:167], a[140:143], v[68:71]
    ds_read_b64_tr_b16 a[182:183], v209 offset:8704
    buffer_load_dwordx4 v195, s[44:47], s27 offen offset:3072 lds
    s_waitcnt lgkmcnt(8)
    v_mfma_f32_16x16x32_bf16 v[24:27], a[168:171], a[128:131], v[24:27]
    ds_read_b64_tr_b16 a[184:185], v212 offset:8192
    v_mfma_f32_16x16x32_bf16 v[40:43], a[168:171], a[132:135], v[40:43]
    ds_read_b64_tr_b16 a[186:187], v212 offset:8704
    v_mfma_f32_16x16x32_bf16 v[56:59], a[168:171], a[136:139], v[56:59]
    ds_read_b64_tr_b16 a[188:189], v215 offset:8192
    v_mfma_f32_16x16x32_bf16 v[72:75], a[168:171], a[140:143], v[72:75]
    ds_read_b64_tr_b16 a[190:191], v215 offset:8704
    v_mfma_f32_16x16x32_bf16 v[28:31], a[172:175], a[128:131], v[28:31]
    v_mfma_f32_16x16x32_bf16 v[44:47], a[172:175], a[132:135], v[44:47]
    s_add_u32 m0, s23, 65536
    s_mul_i32 s29, s27, 1792
    buffer_load_dwordx4 v196, s[48:51], s29 offen offset:0 lds
    v_mfma_f32_16x16x32_bf16 v[60:63], a[172:175], a[136:139], v[60:63]
    v_mfma_f32_16x16x32_bf16 v[76:79], a[172:175], a[140:143], v[76:79]
    buffer_load_dwordx4 v197, s[48:51], s29 offen offset:1024 lds
    buffer_load_dwordx4 v198, s[48:51], s29 offen offset:2048 lds
    buffer_load_dwordx4 v199, s[48:51], s29 offen offset:3072 lds
    s_waitcnt vmcnt(10) lgkmcnt(0)
    s_barrier
    v_mfma_f32_16x16x32_bf16 v[16:19], a[176:179], a[144:147], v[16:19]
    ds_read_b64_tr_b16 a[160:161], v206 offset:32768
    v_mfma_f32_16x16x32_bf16 v[32:35], a[176:179], a[148:151], v[32:35]
    ds_read_b64_tr_b16 a[162:163], v206 offset:33280
    v_mfma_f32_16x16x32_bf16 v[48:51], a[176:179], a[152:155], v[48:51]
    ds_read_b128 a[128:131], v200 offset:32768
    v_mfma_f32_16x16x32_bf16 v[64:67], a[176:179], a[156:159], v[64:67]
    ds_read_b128 a[132:135], v200 offset:34816
    v_mfma_f32_16x16x32_bf16 v[20:23], a[180:183], a[144:147], v[20:23]
    ds_read_b128 a[136:139], v200 offset:36864
    v_mfma_f32_16x16x32_bf16 v[36:39], a[180:183], a[148:151], v[36:39]
    ds_read_b128 a[140:143], v200 offset:38912
    v_mfma_f32_16x16x32_bf16 v[52:55], a[180:183], a[152:155], v[52:55]
    ds_read_b64_tr_b16 a[164:165], v209 offset:32768
    v_mfma_f32_16x16x32_bf16 v[68:71], a[180:183], a[156:159], v[68:71]
    ds_read_b64_tr_b16 a[166:167], v209 offset:33280
    v_mfma_f32_16x16x32_bf16 v[24:27], a[184:187], a[144:147], v[24:27]
    ds_read_b64_tr_b16 a[168:169], v212 offset:32768
    v_mfma_f32_16x16x32_bf16 v[40:43], a[184:187], a[148:151], v[40:43]
    s_waitcnt vmcnt(8)
    ds_read_b64_tr_b16 a[170:171], v212 offset:33280
    v_mov_b32_dpp v148, v144 wave_shl:1 row_mask:0xf bank_mask:0xf
    v_mfma_f32_16x16x32_bf16 v[56:59], a[184:187], a[152:155], v[56:59]
    ds_read_b64_tr_b16 a[172:173], v215 offset:32768
    v_mov_b32_dpp v149, v145 wave_shl:1 row_mask:0xf bank_mask:0xf
    v_mfma_f32_16x16x32_bf16 v[72:75], a[184:187], a[156:159], v[72:75]
    ds_read_b64_tr_b16 a[174:175], v215 offset:33280
    v_mov_b32_dpp v154, v150 wave_shl:1 row_mask:0xf bank_mask:0xf
    v_mfma_f32_16x16x32_bf16 v[28:31], a[188:191], a[144:147], v[28:31]
    s_add_u32 s27, s27, 128
    s_add_u32 m0, s22, 0
    s_and_b32 s27, s27, 1023
    buffer_load_dwordx4 v192, s[44:47], s27 offen offset:0 lds
    v_mfma_f32_16x16x32_bf16 v[44:47], a[188:191], a[148:151], v[44:47]
    v_mov_b32_dpp v155, v151 wave_shl:1 row_mask:0xf bank_mask:0xf
    v_readlane_b32 s24, v150, 0
    v_mfma_f32_16x16x32_bf16 v[60:63], a[188:191], a[152:155], v[60:63]
    v_readlane_b32 s25, v151, 0
    v_writelane_b32 v154, s96, 63
    v_mfma_f32_16x16x32_bf16 v[76:79], a[188:191], a[156:159], v[76:79]
    buffer_load_dwordx4 v193, s[44:47], s27 offen offset:1024 lds
    v_writelane_b32 v155, s97, 63
    s_waitcnt lgkmcnt(4)
    v_mfma_f32_16x16x32_bf16 v[16:19], a[160:163], a[128:131], v[16:19]
    ds_read_b64_tr_b16 a[176:177], v206 offset:40960
    v_writelane_b32 v148, s24, 63
    v_mfma_f32_16x16x32_bf16 v[32:35], a[160:163], a[132:135], v[32:35]
    ds_read_b64_tr_b16 a[178:179], v206 offset:41472
    v_writelane_b32 v149, s25, 63
    v_mfma_f32_16x16x32_bf16 v[48:51], a[160:163], a[136:139], v[48:51]
    ds_read_b128 a[144:147], v203 offset:32768
    v_alignbyte_b32 v156, v145, v144, 2
    v_mfma_f32_16x16x32_bf16 v[64:67], a[160:163], a[140:143], v[64:67]
    ds_read_b128 a[148:151], v203 offset:34816
    v_alignbyte_b32 v157, v146, v145, 2
    v_mfma_f32_16x16x32_bf16 v[20:23], a[164:167], a[128:131], v[20:23]
    ds_read_b128 a[152:155], v203 offset:36864
    buffer_load_dwordx4 v194, s[44:47], s27 offen offset:2048 lds
    v_mfma_f32_16x16x32_bf16 v[36:39], a[164:167], a[132:135], v[36:39]
    ds_read_b128 a[156:159], v203 offset:38912
    v_alignbyte_b32 v158, v147, v146, 2
    v_mfma_f32_16x16x32_bf16 v[52:55], a[164:167], a[136:139], v[52:55]
    ds_read_b64_tr_b16 a[180:181], v209 offset:40960
    v_alignbyte_b32 v159, v148, v147, 2
    v_mfma_f32_16x16x32_bf16 v[68:71], a[164:167], a[140:143], v[68:71]
    ds_read_b64_tr_b16 a[182:183], v209 offset:41472
    v_mov_b32 v160, v145
    s_waitcnt lgkmcnt(8)
    v_mfma_f32_16x16x32_bf16 v[24:27], a[168:171], a[128:131], v[24:27]
    ds_read_b64_tr_b16 a[184:185], v212 offset:40960
    v_mov_b32 v161, v146
    v_mfma_f32_16x16x32_bf16 v[40:43], a[168:171], a[132:135], v[40:43]
    ds_read_b64_tr_b16 a[186:187], v212 offset:41472
    v_mov_b32 v162, v147
    v_mfma_f32_16x16x32_bf16 v[56:59], a[168:171], a[136:139], v[56:59]
    ds_read_b64_tr_b16 a[188:189], v215 offset:40960
    buffer_load_dwordx4 v195, s[44:47], s27 offen offset:3072 lds
    v_mfma_f32_16x16x32_bf16 v[72:75], a[168:171], a[140:143], v[72:75]
    ds_read_b64_tr_b16 a[190:191], v215 offset:41472
    v_mov_b32 v163, v148
    v_mfma_f32_16x16x32_bf16 v[28:31], a[172:175], a[128:131], v[28:31]
    v_mov_b32 v164, v157
    v_mov_b32 v165, v158
    v_mfma_f32_16x16x32_bf16 v[44:47], a[172:175], a[132:135], v[44:47]
    v_mov_b32 v166, v159
    v_alignbyte_b32 v167, v149, v148, 2
    v_mfma_f32_16x16x32_bf16 v[60:63], a[172:175], a[136:139], v[60:63]
    v_alignbyte_b32 v168, v151, v150, 2
    v_alignbyte_b32 v169, v152, v151, 2
    v_mfma_f32_16x16x32_bf16 v[76:79], a[172:175], a[140:143], v[76:79]
    v_alignbyte_b32 v170, v153, v152, 2
    v_alignbyte_b32 v171, v154, v153, 2
    s_add_u32 m0, s23, 0
    s_mul_i32 s29, s27, 1792
    buffer_load_dwordx4 v196, s[48:51], s29 offen offset:0 lds
    buffer_load_dwordx4 v197, s[48:51], s29 offen offset:1024 lds
    buffer_load_dwordx4 v198, s[48:51], s29 offen offset:2048 lds
    buffer_load_dwordx4 v199, s[48:51], s29 offen offset:3072 lds
    s_waitcnt vmcnt(8) lgkmcnt(0)
    s_barrier
    v_mfma_f32_16x16x32_bf16 v[16:19], a[176:179], a[144:147], v[16:19]
    ds_read_b64_tr_b16 a[160:161], v207 offset:0
    v_mov_b32 v172, v151
    v_mfma_f32_16x16x32_bf16 v[32:35], a[176:179], a[148:151], v[32:35]
    ds_read_b64_tr_b16 a[162:163], v207 offset:512
    v_mov_b32 v173, v152
    v_mfma_f32_16x16x32_bf16 v[48:51], a[176:179], a[152:155], v[48:51]
    ds_read_b128 a[128:131], v201 offset:0
    v_mov_b32 v174, v153
    v_mfma_f32_16x16x32_bf16 v[64:67], a[176:179], a[156:159], v[64:67]
    ds_read_b128 a[132:135], v201 offset:2048
    v_mov_b32 v175, v154
    v_mfma_f32_16x16x32_bf16 v[20:23], a[180:183], a[144:147], v[20:23]
    ds_read_b128 a[136:139], v201 offset:4096
    v_mov_b32 v176, v169
    v_mfma_f32_16x16x32_bf16 v[36:39], a[180:183], a[148:151], v[36:39]
    ds_read_b128 a[140:143], v201 offset:6144
    v_mov_b32 v177, v170
    v_mfma_f32_16x16x32_bf16 v[52:55], a[180:183], a[152:155], v[52:55]
    ds_read_b64_tr_b16 a[164:165], v210 offset:0
    v_mov_b32 v178, v171
    v_mfma_f32_16x16x32_bf16 v[68:71], a[180:183], a[156:159], v[68:71]
    ds_read_b64_tr_b16 a[166:167], v210 offset:512
    v_alignbyte_b32 v179, v155, v154, 2
    v_mfma_f32_16x16x32_bf16 v[24:27], a[184:187], a[144:147], v[24:27]
    s_lshl_b32 s24, s94, 16
    ds_read_b64_tr_b16 a[168:169], v213 offset:0
    s_lshr_b32 s25, s94, 16
    v_mfma_f32_16x16x32_bf16 v[40:43], a[184:187], a[148:151], v[40:43]
    s_lshl_b32 s31, s95, 16
    ds_read_b64_tr_b16 a[170:171], v213 offset:512
    s_or_b32 s25, s25, s31
    v_mfma_f32_16x16x32_bf16 v[56:59], a[184:187], a[152:155], v[56:59]
    ds_read_b64_tr_b16 a[172:173], v216 offset:0
    v_mov_b32 v180, 0
    v_mfma_f32_16x16x32_bf16 v[72:75], a[184:187], a[156:159], v[72:75]
    ds_read_b64_tr_b16 a[174:175], v216 offset:512
    v_mov_b32 v181, 0
    v_mfma_f32_16x16x32_bf16 v[28:31], a[188:191], a[144:147], v[28:31]
    s_lshl_b32 s26, s72, 6
    s_add_u32 m0, s22, 98304
    s_or_b32 s26, s26, s80
    buffer_load_dwordx4 v240, s[64:67], s26 offen offset:0 lds
    v_mfma_f32_16x16x32_bf16 v[44:47], a[188:191], a[148:151], v[44:47]
    v_mov_b32 v182, 0
    v_mov_b32 v183, 0
    v_mfma_f32_16x16x32_bf16 v[60:63], a[188:191], a[152:155], v[60:63]
    buffer_load_dwordx4 v241, s[64:67], s26 offen offset:1024 lds
    v_writelane_b32 v183, s24, 3
    v_mfma_f32_16x16x32_bf16 v[76:79], a[188:191], a[156:159], v[76:79]
    v_writelane_b32 v183, s94, 5
    v_writelane_b32 v182, s24, 7
    s_waitcnt lgkmcnt(4)
    v_mfma_f32_16x16x32_bf16 v[16:19], a[160:163], a[128:131], v[16:19]
    ds_read_b64_tr_b16 a[176:177], v207 offset:8192
    buffer_load_dwordx4 v242, s[64:67], s26 offen offset:2048 lds
    v_mfma_f32_16x16x32_bf16 v[32:35], a[160:163], a[132:135], v[32:35]
    ds_read_b64_tr_b16 a[178:179], v207 offset:8704
    v_writelane_b32 v183, s25, 7
    v_mfma_f32_16x16x32_bf16 v[48:51], a[160:163], a[136:139], v[48:51]
    s_add_u32 s24, s18, s36
    ds_read_b128 a[144:147], v204 offset:0
    buffer_load_dwordx4 v243, s[64:67], s26 offen offset:3072 lds
    v_mfma_f32_16x16x32_bf16 v[64:67], a[160:163], a[140:143], v[64:67]
    ds_read_b128 a[148:151], v204 offset:2048
    v_add_u32 v185, s24, v11
    v_mfma_f32_16x16x32_bf16 v[20:23], a[164:167], a[128:131], v[20:23]
    ds_read_b128 a[152:155], v204 offset:4096
    v_bfe_u32 v5, v1, 1, 2
    v_mfma_f32_16x16x32_bf16 v[36:39], a[164:167], a[132:135], v[36:39]
    ds_read_b128 a[156:159], v204 offset:6144
    v_mul_u32_u24 v5, 4160, v5
    v_mfma_f32_16x16x32_bf16 v[52:55], a[164:167], a[136:139], v[52:55]
    ds_read_b64_tr_b16 a[180:181], v210 offset:8192
    v_and_b32 v6, 1, v1
    v_mfma_f32_16x16x32_bf16 v[68:71], a[164:167], a[140:143], v[68:71]
    ds_read_b64_tr_b16 a[182:183], v210 offset:8704
    v_cmp_gt_u32 vcc, 8, v1
    s_waitcnt lgkmcnt(8)
    v_mfma_f32_16x16x32_bf16 v[24:27], a[168:171], a[128:131], v[24:27]
    ds_read_b64_tr_b16 a[184:185], v213 offset:8192
    v_lshl_add_u32 v5, v6, 4, v5
    v_mfma_f32_16x16x32_bf16 v[40:43], a[168:171], a[132:135], v[40:43]
    ds_read_b64_tr_b16 a[186:187], v213 offset:8704
    v_add_u32 v5, s18, v5
    v_mfma_f32_16x16x32_bf16 v[56:59], a[168:171], a[136:139], v[56:59]
    s_add_u32 s24, s20, 4096
    ds_read_b64_tr_b16 a[188:189], v216 offset:8192
    v_subrev_u32 v6, 128, v11
    v_mfma_f32_16x16x32_bf16 v[72:75], a[168:171], a[140:143], v[72:75]
    ds_read_b64_tr_b16 a[190:191], v216 offset:8704
    v_and_b32 v6, 511, v6
    v_mfma_f32_16x16x32_bf16 v[28:31], a[172:175], a[128:131], v[28:31]
    s_lshl_b32 s26, s73, 6
    s_add_u32 m0, s22, 32768
    s_or_b32 s26, s26, s80
    buffer_load_dwordx4 v240, s[64:67], s26 offen offset:0 lds
    v_mfma_f32_16x16x32_bf16 v[44:47], a[172:175], a[132:135], v[44:47]
    v_add_u32 v6, s24, v6
    v_cndmask_b32 v184, v6, v5, vcc
    v_mfma_f32_16x16x32_bf16 v[60:63], a[172:175], a[136:139], v[60:63]
    buffer_load_dwordx4 v241, s[64:67], s26 offen offset:1024 lds
    v_mfma_f32_16x16x32_bf16 v[76:79], a[172:175], a[140:143], v[76:79]
    buffer_load_dwordx4 v242, s[64:67], s26 offen offset:2048 lds
    buffer_load_dwordx4 v243, s[64:67], s26 offen offset:3072 lds
    s_waitcnt vmcnt(8) lgkmcnt(0)
    s_barrier
    v_mfma_f32_16x16x32_bf16 v[16:19], a[176:179], a[144:147], v[16:19]
    ds_read_b64_tr_b16 a[160:161], v206 offset:0
    v_mfma_f32_16x16x32_bf16 v[32:35], a[176:179], a[148:151], v[32:35]
    ds_read_b64_tr_b16 a[162:163], v206 offset:512
    v_mfma_f32_16x16x32_bf16 v[48:51], a[176:179], a[152:155], v[48:51]
    ds_read_b128 a[128:131], v200 offset:0
    v_mfma_f32_16x16x32_bf16 v[64:67], a[176:179], a[156:159], v[64:67]
    ds_read_b128 a[132:135], v200 offset:2048
    v_mfma_f32_16x16x32_bf16 v[20:23], a[180:183], a[144:147], v[20:23]
    ds_read_b128 a[136:139], v200 offset:4096
    v_mfma_f32_16x16x32_bf16 v[36:39], a[180:183], a[148:151], v[36:39]
    ds_read_b128 a[140:143], v200 offset:6144
    v_mfma_f32_16x16x32_bf16 v[52:55], a[180:183], a[152:155], v[52:55]
    ds_read_b64_tr_b16 a[164:165], v209 offset:0
    v_mfma_f32_16x16x32_bf16 v[68:71], a[180:183], a[156:159], v[68:71]
    ds_read_b64_tr_b16 a[166:167], v209 offset:512
    v_mfma_f32_16x16x32_bf16 v[24:27], a[184:187], a[144:147], v[24:27]
    ds_read_b64_tr_b16 a[168:169], v212 offset:0
    v_mfma_f32_16x16x32_bf16 v[40:43], a[184:187], a[148:151], v[40:43]
    ds_read_b64_tr_b16 a[170:171], v212 offset:512
    v_mfma_f32_16x16x32_bf16 v[56:59], a[184:187], a[152:155], v[56:59]
    ds_read_b64_tr_b16 a[172:173], v215 offset:0
    v_mfma_f32_16x16x32_bf16 v[72:75], a[184:187], a[156:159], v[72:75]
    ds_read_b64_tr_b16 a[174:175], v215 offset:512
    v_mfma_f32_16x16x32_bf16 v[28:31], a[188:191], a[144:147], v[28:31]
    s_lshl_b32 s26, s74, 6
    s_add_u32 m0, s22, 49152
    s_or_b32 s26, s26, s80
    buffer_load_dwordx4 v240, s[64:67], s26 offen offset:0 lds
    v_mfma_f32_16x16x32_bf16 v[44:47], a[188:191], a[148:151], v[44:47]
    v_mfma_f32_16x16x32_bf16 v[60:63], a[188:191], a[152:155], v[60:63]
    v_mfma_f32_16x16x32_bf16 v[76:79], a[188:191], a[156:159], v[76:79]
    s_waitcnt lgkmcnt(4)
    v_mfma_f32_16x16x32_bf16 v[16:19], a[160:163], a[128:131], v[16:19]
    ds_read_b64_tr_b16 a[176:177], v206 offset:8192
    v_mfma_f32_16x16x32_bf16 v[32:35], a[160:163], a[132:135], v[32:35]
    ds_read_b64_tr_b16 a[178:179], v206 offset:8704
    v_mfma_f32_16x16x32_bf16 v[48:51], a[160:163], a[136:139], v[48:51]
    ds_read_b128 a[144:147], v203 offset:0
    v_mfma_f32_16x16x32_bf16 v[64:67], a[160:163], a[140:143], v[64:67]
    ds_read_b128 a[148:151], v203 offset:2048
    v_mfma_f32_16x16x32_bf16 v[20:23], a[164:167], a[128:131], v[20:23]
    ds_read_b128 a[152:155], v203 offset:4096
    v_mfma_f32_16x16x32_bf16 v[36:39], a[164:167], a[132:135], v[36:39]
    ds_read_b128 a[156:159], v203 offset:6144
    v_mfma_f32_16x16x32_bf16 v[52:55], a[164:167], a[136:139], v[52:55]
    ds_read_b64_tr_b16 a[180:181], v209 offset:8192
    v_mfma_f32_16x16x32_bf16 v[68:71], a[164:167], a[140:143], v[68:71]
    ds_read_b64_tr_b16 a[182:183], v209 offset:8704
    s_waitcnt lgkmcnt(8)
    v_mfma_f32_16x16x32_bf16 v[24:27], a[168:171], a[128:131], v[24:27]
    ds_read_b64_tr_b16 a[184:185], v212 offset:8192
    v_mfma_f32_16x16x32_bf16 v[40:43], a[168:171], a[132:135], v[40:43]
    ds_read_b64_tr_b16 a[186:187], v212 offset:8704
    buffer_load_dwordx4 v241, s[64:67], s26 offen offset:1024 lds
    v_mfma_f32_16x16x32_bf16 v[56:59], a[168:171], a[136:139], v[56:59]
    ds_read_b64_tr_b16 a[188:189], v215 offset:8192
    v_mfma_f32_16x16x32_bf16 v[72:75], a[168:171], a[140:143], v[72:75]
    ds_read_b64_tr_b16 a[190:191], v215 offset:8704
    v_mfma_f32_16x16x32_bf16 v[28:31], a[172:175], a[128:131], v[28:31]
    v_mfma_f32_16x16x32_bf16 v[44:47], a[172:175], a[132:135], v[44:47]
    v_mfma_f32_16x16x32_bf16 v[60:63], a[172:175], a[136:139], v[60:63]
    v_mfma_f32_16x16x32_bf16 v[76:79], a[172:175], a[140:143], v[76:79]
    buffer_load_dwordx4 v242, s[64:67], s26 offen offset:2048 lds
    s_waitcnt lgkmcnt(0)
    s_barrier
    v_mfma_f32_16x16x32_bf16 v[16:19], a[176:179], a[144:147], v[16:19]
    v_mfma_f32_16x16x32_bf16 v[32:35], a[176:179], a[148:151], v[32:35]
    v_mfma_f32_16x16x32_bf16 v[48:51], a[176:179], a[152:155], v[48:51]
    buffer_load_dwordx4 v243, s[64:67], s26 offen offset:3072 lds
    v_mfma_f32_16x16x32_bf16 v[64:67], a[176:179], a[156:159], v[64:67]
    v_mfma_f32_16x16x32_bf16 v[20:23], a[180:183], a[144:147], v[20:23]
    v_mfma_f32_16x16x32_bf16 v[36:39], a[180:183], a[148:151], v[36:39]
    v_mfma_f32_16x16x32_bf16 v[52:55], a[180:183], a[152:155], v[52:55]
    v_mfma_f32_16x16x32_bf16 v[68:71], a[180:183], a[156:159], v[68:71]
    s_lshl_b32 s26, s75, 6
    s_add_u32 m0, s22, 65536
    s_or_b32 s26, s26, s80
    buffer_load_dwordx4 v240, s[64:67], s26 offen offset:0 lds
    v_mfma_f32_16x16x32_bf16 v[24:27], a[184:187], a[144:147], v[24:27]
    v_mfma_f32_16x16x32_bf16 v[40:43], a[184:187], a[148:151], v[40:43]
    v_mfma_f32_16x16x32_bf16 v[56:59], a[184:187], a[152:155], v[56:59]
    v_mfma_f32_16x16x32_bf16 v[72:75], a[184:187], a[156:159], v[72:75]
    v_mfma_f32_16x16x32_bf16 v[28:31], a[188:191], a[144:147], v[28:31]
    v_mfma_f32_16x16x32_bf16 v[44:47], a[188:191], a[148:151], v[44:47]
    buffer_load_dwordx4 v241, s[64:67], s26 offen offset:1024 lds
    v_mfma_f32_16x16x32_bf16 v[60:63], a[188:191], a[152:155], v[60:63]
    v_mfma_f32_16x16x32_bf16 v[76:79], a[188:191], a[156:159], v[76:79]
    v_lshlrev_b32 v218, 3, v1
    s_lshl_b32 s92, s4, 9
    s_add_u32 s92, s92, 12648448
    buffer_load_dwordx2 v[220:221], v218, s[52:55], s92 offen sc1
    v_pk_mul_f32 v[224:225], v[16:17], s[16:17]
    v_pk_mul_f32 v[226:227], v[18:19], s[16:17]
    v_exp_f32 v224, v224
    v_exp_f32 v225, v225
    v_exp_f32 v226, v226
    v_exp_f32 v227, v227
    v_pk_add_f32 v[224:225], v[224:225], 1.0 op_sel_hi:[1,0]
    v_pk_add_f32 v[226:227], v[226:227], 1.0 op_sel_hi:[1,0]
    v_rcp_f32 v224, v224
    v_rcp_f32 v225, v225
    v_rcp_f32 v226, v226
    v_rcp_f32 v227, v227
    v_pk_mul_f32 v[224:225], v[224:225], v[16:17]
    v_pk_mul_f32 v[226:227], v[226:227], v[18:19]
    v_cvt_pk_bf16_f32 v16, v224, v225
    v_cvt_pk_bf16_f32 v17, v226, v227
    v_pk_mul_f32 v[228:229], v[20:21], s[16:17]
    v_pk_mul_f32 v[230:231], v[22:23], s[16:17]
    v_exp_f32 v228, v228
    v_exp_f32 v229, v229
    v_exp_f32 v230, v230
    v_exp_f32 v231, v231
    v_pk_add_f32 v[228:229], v[228:229], 1.0 op_sel_hi:[1,0]
    v_pk_add_f32 v[230:231], v[230:231], 1.0 op_sel_hi:[1,0]
    s_waitcnt vmcnt(11)
    ds_read_b64_tr_b16 v[80:81], v236 offset:32768
    ds_read_b64_tr_b16 v[82:83], v236 offset:33280
    ds_read_b64_tr_b16 v[84:85], v237 offset:32768
    ds_read_b64_tr_b16 v[86:87], v237 offset:33280
    ds_read_b64_tr_b16 v[88:89], v238 offset:32768
    ds_read_b64_tr_b16 v[90:91], v238 offset:33280
    ds_read_b64_tr_b16 v[92:93], v239 offset:32768
    ds_read_b64_tr_b16 v[94:95], v239 offset:33280
    v_rcp_f32 v228, v228
    v_rcp_f32 v229, v229
    v_rcp_f32 v230, v230
    v_rcp_f32 v231, v231
    v_pk_mul_f32 v[228:229], v[228:229], v[20:21]
    v_pk_mul_f32 v[230:231], v[230:231], v[22:23]
    v_cvt_pk_bf16_f32 v18, v228, v229
    v_cvt_pk_bf16_f32 v19, v230, v231
    buffer_store_dwordx4 v[16:19], v219, s[52:55], s12 offen
    v_pk_mul_f32 v[224:225], v[32:33], s[16:17]
    v_pk_mul_f32 v[226:227], v[34:35], s[16:17]
    v_exp_f32 v224, v224
    v_exp_f32 v225, v225
    v_exp_f32 v226, v226
    v_exp_f32 v227, v227
    v_pk_add_f32 v[224:225], v[224:225], 1.0 op_sel_hi:[1,0]
    v_pk_add_f32 v[226:227], v[226:227], 1.0 op_sel_hi:[1,0]
    v_rcp_f32 v224, v224
    v_rcp_f32 v225, v225
    v_rcp_f32 v226, v226
    v_rcp_f32 v227, v227
    v_pk_mul_f32 v[224:225], v[224:225], v[32:33]
    v_pk_mul_f32 v[226:227], v[226:227], v[34:35]
    v_cvt_pk_bf16_f32 v32, v224, v225
    v_cvt_pk_bf16_f32 v33, v226, v227
    v_pk_mul_f32 v[228:229], v[36:37], s[16:17]
    v_pk_mul_f32 v[230:231], v[38:39], s[16:17]
    v_exp_f32 v228, v228
    v_exp_f32 v229, v229
    v_exp_f32 v230, v230
    v_exp_f32 v231, v231
    v_pk_add_f32 v[228:229], v[228:229], 1.0 op_sel_hi:[1,0]
    v_pk_add_f32 v[230:231], v[230:231], 1.0 op_sel_hi:[1,0]
    v_rcp_f32 v228, v228
    v_rcp_f32 v229, v229
    v_rcp_f32 v230, v230
    v_rcp_f32 v231, v231
    v_pk_mul_f32 v[228:229], v[228:229], v[36:37]
    v_pk_mul_f32 v[230:231], v[230:231], v[38:39]
    v_cvt_pk_bf16_f32 v34, v228, v229
    v_cvt_pk_bf16_f32 v35, v230, v231
    buffer_store_dwordx4 v[32:35], v219, s[52:55], s13 offen
    v_pk_mul_f32 v[224:225], v[48:49], s[16:17]
    v_pk_mul_f32 v[226:227], v[50:51], s[16:17]
    v_exp_f32 v224, v224
    s_waitcnt vmcnt(9)
    ds_read_b64_tr_b16 v[96:97], v232 offset:32768
    ds_read_b64_tr_b16 v[98:99], v232 offset:33280
    ds_read_b64_tr_b16 v[100:101], v233 offset:32768
    ds_read_b64_tr_b16 v[102:103], v233 offset:33280
    ds_read_b64_tr_b16 v[104:105], v234 offset:32768
    ds_read_b64_tr_b16 v[106:107], v234 offset:33280
    ds_read_b64_tr_b16 v[108:109], v235 offset:32768
    ds_read_b64_tr_b16 v[110:111], v235 offset:33280
    v_exp_f32 v225, v225
    v_exp_f32 v226, v226
    v_exp_f32 v227, v227
    v_pk_add_f32 v[224:225], v[224:225], 1.0 op_sel_hi:[1,0]
    v_pk_add_f32 v[226:227], v[226:227], 1.0 op_sel_hi:[1,0]
    v_rcp_f32 v224, v224
    v_rcp_f32 v225, v225
    v_rcp_f32 v226, v226
    v_rcp_f32 v227, v227
    v_pk_mul_f32 v[224:225], v[224:225], v[48:49]
    v_pk_mul_f32 v[226:227], v[226:227], v[50:51]
    v_cvt_pk_bf16_f32 v48, v224, v225
    v_cvt_pk_bf16_f32 v49, v226, v227
    v_pk_mul_f32 v[228:229], v[52:53], s[16:17]
    v_pk_mul_f32 v[230:231], v[54:55], s[16:17]
    v_exp_f32 v228, v228
    v_exp_f32 v229, v229
    v_exp_f32 v230, v230
    v_exp_f32 v231, v231
    v_pk_add_f32 v[228:229], v[228:229], 1.0 op_sel_hi:[1,0]
    v_pk_add_f32 v[230:231], v[230:231], 1.0 op_sel_hi:[1,0]
    v_rcp_f32 v228, v228
    v_rcp_f32 v229, v229
    v_rcp_f32 v230, v230
    v_rcp_f32 v231, v231
    v_pk_mul_f32 v[228:229], v[228:229], v[52:53]
    v_pk_mul_f32 v[230:231], v[230:231], v[54:55]
    v_cvt_pk_bf16_f32 v50, v228, v229
    v_cvt_pk_bf16_f32 v51, v230, v231
    buffer_store_dwordx4 v[48:51], v219, s[52:55], s14 offen
    v_pk_mul_f32 v[224:225], v[64:65], s[16:17]
    v_pk_mul_f32 v[226:227], v[66:67], s[16:17]
    v_exp_f32 v224, v224
    v_exp_f32 v225, v225
    v_exp_f32 v226, v226
    v_exp_f32 v227, v227
    v_pk_add_f32 v[224:225], v[224:225], 1.0 op_sel_hi:[1,0]
    v_pk_add_f32 v[226:227], v[226:227], 1.0 op_sel_hi:[1,0]
    v_rcp_f32 v224, v224
    v_rcp_f32 v225, v225
    v_rcp_f32 v226, v226
    v_rcp_f32 v227, v227
    v_pk_mul_f32 v[224:225], v[224:225], v[64:65]
    v_pk_mul_f32 v[226:227], v[226:227], v[66:67]
    v_cvt_pk_bf16_f32 v64, v224, v225
    v_cvt_pk_bf16_f32 v65, v226, v227
    v_pk_mul_f32 v[228:229], v[68:69], s[16:17]
    v_pk_mul_f32 v[230:231], v[70:71], s[16:17]
    v_exp_f32 v228, v228
    v_exp_f32 v229, v229
    v_exp_f32 v230, v230
    v_exp_f32 v231, v231
    v_pk_add_f32 v[228:229], v[228:229], 1.0 op_sel_hi:[1,0]
    v_pk_add_f32 v[230:231], v[230:231], 1.0 op_sel_hi:[1,0]
    v_rcp_f32 v228, v228
    v_rcp_f32 v229, v229
    v_rcp_f32 v230, v230
    v_rcp_f32 v231, v231
    v_pk_mul_f32 v[228:229], v[228:229], v[68:69]
    v_pk_mul_f32 v[230:231], v[230:231], v[70:71]
    v_cvt_pk_bf16_f32 v66, v228, v229
    v_cvt_pk_bf16_f32 v67, v230, v231
    buffer_store_dwordx4 v[64:67], v219, s[52:55], s15 offen
    v_lshlrev_b32 v14, 3, v3
    s_lshl_b32 s93, s4, 7
    s_add_u32 s93, s93, 12652544
    buffer_load_dwordx2 v[248:249], v14, s[52:55], s93 offen sc1
    v_pk_mul_f32 v[224:225], v[24:25], s[16:17]
    v_pk_mul_f32 v[226:227], v[26:27], s[16:17]
    v_exp_f32 v224, v224
    v_exp_f32 v225, v225
    v_exp_f32 v226, v226
    v_exp_f32 v227, v227
    v_pk_add_f32 v[224:225], v[224:225], 1.0 op_sel_hi:[1,0]
    v_pk_add_f32 v[226:227], v[226:227], 1.0 op_sel_hi:[1,0]
    v_rcp_f32 v224, v224
    v_rcp_f32 v225, v225
    s_waitcnt vmcnt(8)
    ds_read_b64_tr_b16 v[112:113], v232 offset:49152
    ds_read_b64_tr_b16 v[114:115], v232 offset:49664
    ds_read_b64_tr_b16 v[116:117], v233 offset:49152
    ds_read_b64_tr_b16 v[118:119], v233 offset:49664
    ds_read_b64_tr_b16 v[120:121], v234 offset:49152
    ds_read_b64_tr_b16 v[122:123], v234 offset:49664
    ds_read_b64_tr_b16 v[124:125], v235 offset:49152
    ds_read_b64_tr_b16 v[126:127], v235 offset:49664
    v_rcp_f32 v226, v226
    v_rcp_f32 v227, v227
    v_pk_mul_f32 v[224:225], v[224:225], v[24:25]
    v_pk_mul_f32 v[226:227], v[226:227], v[26:27]
    v_cvt_pk_bf16_f32 v24, v224, v225
    buffer_load_dwordx4 v242, s[64:67], s26 offen offset:2048 lds
    buffer_load_dwordx4 v243, s[64:67], s26 offen offset:3072 lds
    v_cvt_pk_bf16_f32 v25, v226, v227
    v_pk_mul_f32 v[228:229], v[28:29], s[16:17]
    v_pk_mul_f32 v[230:231], v[30:31], s[16:17]
    v_exp_f32 v228, v228
    v_exp_f32 v229, v229
    v_exp_f32 v230, v230
    v_exp_f32 v231, v231
    v_pk_add_f32 v[228:229], v[228:229], 1.0 op_sel_hi:[1,0]
    v_pk_add_f32 v[230:231], v[230:231], 1.0 op_sel_hi:[1,0]
    v_rcp_f32 v228, v228
    v_rcp_f32 v229, v229
    v_rcp_f32 v230, v230
    v_rcp_f32 v231, v231
    v_pk_mul_f32 v[228:229], v[228:229], v[28:29]
    v_pk_mul_f32 v[230:231], v[230:231], v[30:31]
    v_cvt_pk_bf16_f32 v26, v228, v229
    v_cvt_pk_bf16_f32 v27, v230, v231
    buffer_store_dwordx4 v[24:27], v15, s[52:55], s12 offen
    ds_write_b128 v185, v[144:147] offset:32
    ds_write_b128 v185, v[156:159] offset:4192
    ds_write_b128 v185, v[160:163] offset:8352
    ds_write_b128 v185, v[164:167] offset:12512
    ds_write_b128 v185, v[150:153] offset:1056
    s_waitcnt vmcnt(8)
    v_cmp_eq_u64 vcc, s[90:91], v[220:221]
    s_mov_b32 s30, 0
    s_cmp_eq_u32 vcc_lo, -1
    s_cbranch_scc0 L_mc_6
L_md_7:
    v_mov_b32 v13, s89
    s_lshl_b32 s26, s76, 6
    s_add_u32 m0, s22, 81920
    s_or_b32 s26, s26, s80
    buffer_load_dwordx4 v240, s[64:67], s26 offen offset:0 lds
    s_waitcnt vmcnt(4)
    v_cmp_ne_u64 vcc, s[88:89], v[248:249]
    s_cbranch_vccnz L_pl_8
L_pd_9:
    buffer_load_dwordx4 v241, s[64:67], s26 offen offset:1024 lds
    buffer_load_dwordx4 v242, s[64:67], s26 offen offset:2048 lds
    buffer_load_dwordx4 v243, s[64:67], s26 offen offset:3072 lds
    s_add_u32 m0, s20, s36
    s_add_u32 s38, s37, 0
    buffer_load_dwordx4 v11, s[52:55], s38 offen sc1 lds
    buffer_load_dwordx4 v11, s[52:55], s38 offen offset:1024 sc1 lds
    v_pk_mul_f32 v[224:225], v[40:41], s[16:17]
    v_pk_mul_f32 v[226:227], v[42:43], s[16:17]
    s_lshl_b32 s26, s77, 6
    s_add_u32 m0, s22, 0
    s_or_b32 s26, s26, s80
    buffer_load_dwordx4 v240, s[64:67], s26 offen offset:0 lds
    buffer_load_dwordx4 v241, s[64:67], s26 offen offset:1024 lds
    v_exp_f32 v224, v224
    v_exp_f32 v225, v225
    v_exp_f32 v226, v226
    v_exp_f32 v227, v227
    v_pk_add_f32 v[224:225], v[224:225], 1.0 op_sel_hi:[1,0]
    v_pk_add_f32 v[226:227], v[226:227], 1.0 op_sel_hi:[1,0]
    v_rcp_f32 v224, v224
    v_rcp_f32 v225, v225
    v_rcp_f32 v226, v226
    v_rcp_f32 v227, v227
    v_pk_mul_f32 v[224:225], v[224:225], v[40:41]
    v_pk_mul_f32 v[226:227], v[226:227], v[42:43]
    v_cvt_pk_bf16_f32 v40, v224, v225
    v_cvt_pk_bf16_f32 v41, v226, v227
    v_pk_mul_f32 v[228:229], v[44:45], s[16:17]
    v_pk_mul_f32 v[230:231], v[46:47], s[16:17]
    v_exp_f32 v228, v228
    v_exp_f32 v229, v229
    v_exp_f32 v230, v230
    v_exp_f32 v231, v231
    v_pk_add_f32 v[228:229], v[228:229], 1.0 op_sel_hi:[1,0]
    v_pk_add_f32 v[230:231], v[230:231], 1.0 op_sel_hi:[1,0]
    v_rcp_f32 v228, v228
    v_rcp_f32 v229, v229
    v_rcp_f32 v230, v230
    v_rcp_f32 v231, v231
    v_pk_mul_f32 v[228:229], v[228:229], v[44:45]
    v_pk_mul_f32 v[230:231], v[230:231], v[46:47]
    v_cvt_pk_bf16_f32 v42, v228, v229
    v_cvt_pk_bf16_f32 v43, v230, v231
    buffer_store_dwordx4 v[40:43], v15, s[52:55], s13 offen
    v_pk_mul_f32 v[224:225], v[56:57], s[16:17]
    v_pk_mul_f32 v[226:227], v[58:59], s[16:17]
    v_exp_f32 v224, v224
    v_exp_f32 v225, v225
    v_exp_f32 v226, v226
    v_exp_f32 v227, v227
    v_pk_add_f32 v[224:225], v[224:225], 1.0 op_sel_hi:[1,0]
    v_pk_add_f32 v[226:227], v[226:227], 1.0 op_sel_hi:[1,0]
    v_rcp_f32 v224, v224
    v_rcp_f32 v225, v225
    v_rcp_f32 v226, v226
    v_rcp_f32 v227, v227
    v_pk_mul_f32 v[224:225], v[224:225], v[56:57]
    v_pk_mul_f32 v[226:227], v[226:227], v[58:59]
    v_cvt_pk_bf16_f32 v56, v224, v225
    v_cvt_pk_bf16_f32 v57, v226, v227
    v_pk_mul_f32 v[228:229], v[60:61], s[16:17]
    v_pk_mul_f32 v[230:231], v[62:63], s[16:17]
    v_exp_f32 v228, v228
    v_exp_f32 v229, v229
    v_exp_f32 v230, v230
    v_exp_f32 v231, v231
    v_pk_add_f32 v[228:229], v[228:229], 1.0 op_sel_hi:[1,0]
    v_pk_add_f32 v[230:231], v[230:231], 1.0 op_sel_hi:[1,0]
    v_rcp_f32 v228, v228
    v_rcp_f32 v229, v229
    v_rcp_f32 v230, v230
    v_rcp_f32 v231, v231
    v_pk_mul_f32 v[228:229], v[228:229], v[60:61]
    v_pk_mul_f32 v[230:231], v[230:231], v[62:63]
    v_cvt_pk_bf16_f32 v58, v228, v229
    v_cvt_pk_bf16_f32 v59, v230, v231
    buffer_store_dwordx4 v[56:59], v15, s[52:55], s14 offen
    v_pk_mul_f32 v[224:225], v[72:73], s[16:17]
    v_pk_mul_f32 v[226:227], v[74:75], s[16:17]
    v_exp_f32 v224, v224
    v_exp_f32 v225, v225
    v_exp_f32 v226, v226
    v_exp_f32 v227, v227
    v_pk_add_f32 v[224:225], v[224:225], 1.0 op_sel_hi:[1,0]
    v_pk_add_f32 v[226:227], v[226:227], 1.0 op_sel_hi:[1,0]
    v_rcp_f32 v224, v224
    v_rcp_f32 v225, v225
    v_rcp_f32 v226, v226
    v_rcp_f32 v227, v227
    v_pk_mul_f32 v[224:225], v[224:225], v[72:73]
    v_pk_mul_f32 v[226:227], v[226:227], v[74:75]
    v_cvt_pk_bf16_f32 v72, v224, v225
    v_cvt_pk_bf16_f32 v73, v226, v227
    v_pk_mul_f32 v[228:229], v[76:77], s[16:17]
    v_pk_mul_f32 v[230:231], v[78:79], s[16:17]
    v_exp_f32 v228, v228
    v_exp_f32 v229, v229
    v_exp_f32 v230, v230
    v_exp_f32 v231, v231
    v_pk_add_f32 v[228:229], v[228:229], 1.0 op_sel_hi:[1,0]
    v_pk_add_f32 v[230:231], v[230:231], 1.0 op_sel_hi:[1,0]
    v_rcp_f32 v228, v228
    v_rcp_f32 v229, v229
    v_rcp_f32 v230, v230
    v_rcp_f32 v231, v231
    v_pk_mul_f32 v[228:229], v[228:229], v[76:77]
    v_pk_mul_f32 v[230:231], v[230:231], v[78:79]
    v_cvt_pk_bf16_f32 v74, v228, v229
    v_cvt_pk_bf16_f32 v75, v230, v231
    buffer_store_dwordx4 v[72:75], v15, s[52:55], s15 offen
    s_add_u32 s92, s11, 0
    s_cmp_lg_u32 s30, 0
    s_cbranch_scc1 L_fs_10
    s_mov_b64 exec, 1
    buffer_store_dwordx2 v[12:13], v10, s[52:55], s92 offen
    s_mov_b64 exec, -1
L_fd_11:
    ds_write_b128 v185, v[168:171] offset:5216
    ds_write_b128 v185, v[172:175] offset:9376
    ds_write_b128 v185, v[176:179] offset:13536
    ds_write_b128 v184, v[180:183]
    s_waitcnt vmcnt(12)
    ds_read_b64_tr_b16 v[128:129], v236 offset:0
    ds_read_b64_tr_b16 v[130:131], v236 offset:512
    ds_read_b64_tr_b16 v[132:133], v237 offset:0
    ds_read_b64_tr_b16 v[134:135], v237 offset:512
    ds_read_b64_tr_b16 v[136:137], v238 offset:0
    ds_read_b64_tr_b16 v[138:139], v238 offset:512
    ds_read_b64_tr_b16 v[140:141], v239 offset:0
    ds_read_b64_tr_b16 v[142:143], v239 offset:512
    buffer_load_dwordx4 v242, s[64:67], s26 offen offset:2048 lds
    buffer_load_dwordx4 v243, s[64:67], s26 offen offset:3072 lds
    s_lshl_b32 s26, s78, 6
    s_add_u32 m0, s22, 16384
    s_or_b32 s26, s26, s80
    buffer_load_dwordx4 v240, s[64:67], s26 offen offset:0 lds
    buffer_load_dwordx4 v241, s[64:67], s26 offen offset:1024 lds
    s_waitcnt vmcnt(9) lgkmcnt(8)
    s_barrier
    ds_read_b64 a[0:1], v250 offset:0
    ds_read_b64 a[2:3], v250 offset:8
    ds_read_b128 a[32:35], v251 offset:3584
    ds_read_b64 a[4:5], v250 offset:512
    ds_read_b64 a[6:7], v250 offset:520
    ds_read_b128 a[36:39], v251 offset:3072
    ds_read_b64 a[8:9], v250 offset:1024
    ds_read_b64 a[10:11], v250 offset:1032
    ds_read_b128 a[40:43], v251 offset:2560
    ds_read_b64 a[12:13], v250 offset:1536
    ds_read_b64 a[14:15], v250 offset:1544
    ds_read_b128 a[44:47], v251 offset:2048
    ds_read_b64 a[16:17], v250 offset:2048
    ds_read_b64 a[18:19], v250 offset:2056
    ds_read_b128 a[48:51], v251 offset:1536
    ds_read_b64 a[20:21], v250 offset:2560
    ds_read_b64 a[22:23], v250 offset:2568
    ds_read_b128 a[52:55], v251 offset:1024
    ds_read_b64 a[24:25], v250 offset:3072
    ds_read_b64 a[26:27], v250 offset:3080
    ds_read_b128 a[56:59], v251 offset:512
    ds_read_b64 a[28:29], v250 offset:3584
    ds_read_b64 a[30:31], v250 offset:3592
    ds_read_b128 a[60:63], v251 offset:0
    s_waitcnt lgkmcnt(15)
    v_mfma_f32_16x16x32_bf16 v[192:195], a[0:3], a[32:35], 0
    buffer_load_dwordx4 v242, s[64:67], s26 offen offset:2048 lds
    v_mfma_f32_16x16x32_bf16 v[196:199], a[0:3], a[36:39], 0
    v_mfma_f32_16x16x32_bf16 v[196:199], a[4:7], a[32:35], v[196:199]
    ds_read_b64_tr_b16 v[144:145], v236 offset:16384
    buffer_load_dwordx4 v243, s[64:67], s26 offen offset:3072 lds
    v_mfma_f32_16x16x32_bf16 v[200:203], a[4:7], a[36:39], 0
    ds_read_b64_tr_b16 v[146:147], v236 offset:16896
    v_mfma_f32_16x16x32_bf16 v[200:203], a[0:3], a[40:43], v[200:203]
    ds_read_b64_tr_b16 v[148:149], v237 offset:16384
    v_mfma_f32_16x16x32_bf16 v[200:203], a[8:11], a[32:35], v[200:203]
    ds_read_b64_tr_b16 v[150:151], v237 offset:16896
    v_mfma_f32_16x16x32_bf16 v[204:207], a[4:7], a[40:43], 0
    ds_read_b64_tr_b16 v[152:153], v238 offset:16384
    v_mfma_f32_16x16x32_bf16 v[204:207], a[8:11], a[36:39], v[204:207]
    ds_read_b64_tr_b16 v[154:155], v238 offset:16896
    v_mfma_f32_16x16x32_bf16 v[208:211], a[8:11], a[40:43], 0
    ds_read_b64_tr_b16 v[156:157], v239 offset:16384
    s_waitcnt lgkmcnt(15)
    v_mfma_f32_16x16x32_bf16 v[204:207], a[0:3], a[44:47], v[204:207]
    ds_read_b64_tr_b16 v[158:159], v239 offset:16896
    v_mfma_f32_16x16x32_bf16 v[204:207], a[12:15], a[32:35], v[204:207]
    s_lshl_b32 s26, s72, 6
    s_add_u32 m0, s22, 98304
    s_or_b32 s26, s26, s81
    buffer_load_dwordx4 v240, s[64:67], s26 offen offset:0 lds
    v_mfma_f32_16x16x32_bf16 v[208:211], a[4:7], a[44:47], v[208:211]
    ds_read_b64 a[64:65], v250 offset:64
    v_mfma_f32_16x16x32_bf16 v[208:211], a[12:15], a[36:39], v[208:211]
    buffer_load_dwordx4 v241, s[64:67], s26 offen offset:1024 lds
    v_mfma_f32_16x16x32_bf16 v[212:215], a[8:11], a[44:47], 0
    ds_read_b64 a[66:67], v250 offset:72
    buffer_load_dwordx4 v242, s[64:67], s26 offen offset:2048 lds
    v_mfma_f32_16x16x32_bf16 v[212:215], a[12:15], a[40:43], v[212:215]
    ds_read_b128 a[96:99], v251 offset:3648
    v_mfma_f32_16x16x32_bf16 v[216:219], a[12:15], a[44:47], 0
    buffer_load_dwordx4 v243, s[64:67], s26 offen offset:3072 lds
    v_mfma_f32_16x16x32_bf16 v[208:211], a[0:3], a[48:51], v[208:211]
    s_add_u32 s92, s11, 256
    s_waitcnt vmcnt(10)
    s_cmp_lg_u32 s30, 0
    s_cbranch_scc1 L_fs_12
    s_mov_b64 exec, 1
    buffer_store_dwordx2 v[12:13], v10, s[52:55], s92 offen
    s_mov_b64 exec, -1
L_fd_13:
    v_mfma_f32_16x16x32_bf16 v[208:211], a[16:19], a[32:35], v[208:211]
    ds_read_b64 a[68:69], v250 offset:576
    v_mfma_f32_16x16x32_bf16 v[212:215], a[4:7], a[48:51], v[212:215]
    ds_read_b64 a[70:71], v250 offset:584
    v_mfma_f32_16x16x32_bf16 v[212:215], a[16:19], a[36:39], v[212:215]
    ds_read_b128 a[100:103], v251 offset:3136
    v_mfma_f32_16x16x32_bf16 v[216:219], a[8:11], a[48:51], v[216:219]
    ds_read_b64 a[72:73], v250 offset:1088
    v_mfma_f32_16x16x32_bf16 v[216:219], a[16:19], a[40:43], v[216:219]
    ds_read_b64 a[74:75], v250 offset:1096
    v_mfma_f32_16x16x32_bf16 v[220:223], a[12:15], a[48:51], 0
    ds_read_b128 a[104:107], v251 offset:2624
    v_mfma_f32_16x16x32_bf16 v[220:223], a[16:19], a[44:47], v[220:223]
    ds_read_b64 a[76:77], v250 offset:1600
    s_waitcnt lgkmcnt(15)
    v_mfma_f32_16x16x32_bf16 v[212:215], a[0:3], a[52:55], v[212:215]
    ds_read_b64 a[78:79], v250 offset:1608
    v_mfma_f32_16x16x32_bf16 v[212:215], a[20:23], a[32:35], v[212:215]
    ds_read_b128 a[108:111], v251 offset:2112
    v_mfma_f32_16x16x32_bf16 v[216:219], a[4:7], a[52:55], v[216:219]
    ds_read_b64 a[80:81], v250 offset:2112
    v_mfma_f32_16x16x32_bf16 v[216:219], a[20:23], a[36:39], v[216:219]
    ds_read_b64 a[82:83], v250 offset:2120
    v_mfma_f32_16x16x32_bf16 v[220:223], a[8:11], a[52:55], v[220:223]
    s_lshl_b32 s26, s73, 6
    s_add_u32 m0, s22, 32768
    s_or_b32 s26, s26, s81
    buffer_load_dwordx4 v240, s[64:67], s26 offen offset:0 lds
    v_mfma_f32_16x16x32_bf16 v[220:223], a[20:23], a[40:43], v[220:223]
    ds_read_b128 a[112:115], v251 offset:1600
    v_mfma_f32_16x16x32_bf16 v[216:219], a[0:3], a[56:59], v[216:219]
    ds_read_b64 a[84:85], v250 offset:2624
    v_mfma_f32_16x16x32_bf16 v[216:219], a[24:27], a[32:35], v[216:219]
    ds_read_b64 a[86:87], v250 offset:2632
    v_mfma_f32_16x16x32_bf16 v[220:223], a[4:7], a[56:59], v[220:223]
    ds_read_b128 a[116:119], v251 offset:1088
    v_mfma_f32_16x16x32_bf16 v[220:223], a[24:27], a[36:39], v[220:223]
    ds_read_b64 a[88:89], v250 offset:3136
    v_mfma_f32_16x16x32_bf16 v[220:223], a[0:3], a[60:63], v[220:223]
    buffer_load_dwordx4 v241, s[64:67], s26 offen offset:1024 lds
    v_mfma_f32_16x16x32_bf16 v[220:223], a[28:31], a[32:35], v[220:223]
    ds_read_b64 a[90:91], v250 offset:3144
    ds_read_b128 a[120:123], v251 offset:576
    ds_read_b64 a[92:93], v250 offset:3648
    ds_read_b64 a[94:95], v250 offset:3656
    ds_read_b128 a[124:127], v251 offset:64
    s_waitcnt lgkmcnt(15)
    v_mfma_f32_16x16x32_bf16 v[192:195], a[64:67], a[96:99], v[192:195]
    ds_read_b64 a[0:1], v250 offset:128
    v_mfma_f32_16x16x32_bf16 v[196:199], a[64:67], a[100:103], v[196:199]
    ds_read_b64 a[2:3], v250 offset:136
    v_mfma_f32_16x16x32_bf16 v[196:199], a[68:71], a[96:99], v[196:199]
    buffer_load_dwordx4 v242, s[64:67], s26 offen offset:2048 lds
    v_mfma_f32_16x16x32_bf16 v[200:203], a[68:71], a[100:103], v[200:203]
    ds_read_b128 a[32:35], v251 offset:3712
    v_mfma_f32_16x16x32_bf16 v[200:203], a[64:67], a[104:107], v[200:203]
    ds_read_b64 a[4:5], v250 offset:640
    v_mfma_f32_16x16x32_bf16 v[200:203], a[72:75], a[96:99], v[200:203]
    ds_read_b64 a[6:7], v250 offset:648
    v_mfma_f32_16x16x32_bf16 v[204:207], a[68:71], a[104:107], v[204:207]
    ds_read_b128 a[36:39], v251 offset:3200
    v_mfma_f32_16x16x32_bf16 v[204:207], a[72:75], a[100:103], v[204:207]
    ds_read_b64 a[8:9], v250 offset:1152
    buffer_load_dwordx4 v243, s[64:67], s26 offen offset:3072 lds
    v_mfma_f32_16x16x32_bf16 v[208:211], a[72:75], a[104:107], v[208:211]
    ds_read_b64 a[10:11], v250 offset:1160
    s_waitcnt lgkmcnt(15)
    v_mfma_f32_16x16x32_bf16 v[204:207], a[64:67], a[108:111], v[204:207]
    ds_read_b128 a[40:43], v251 offset:2688
    v_mfma_f32_16x16x32_bf16 v[204:207], a[76:79], a[96:99], v[204:207]
    ds_read_b64 a[12:13], v250 offset:1664
    v_mfma_f32_16x16x32_bf16 v[208:211], a[68:71], a[108:111], v[208:211]
    ds_read_b64 a[14:15], v250 offset:1672
    v_mfma_f32_16x16x32_bf16 v[208:211], a[76:79], a[100:103], v[208:211]
    ds_read_b128 a[44:47], v251 offset:2176
    v_mfma_f32_16x16x32_bf16 v[212:215], a[72:75], a[108:111], v[212:215]
    ds_read_b64 a[16:17], v250 offset:2176
    v_mfma_f32_16x16x32_bf16 v[212:215], a[76:79], a[104:107], v[212:215]
    ds_read_b64 a[18:19], v250 offset:2184
    v_mfma_f32_16x16x32_bf16 v[216:219], a[76:79], a[108:111], v[216:219]
    s_waitcnt vmcnt(12)
    ds_read_b64_tr_b16 v[160:161], v232 offset:0
    v_mfma_f32_16x16x32_bf16 v[208:211], a[64:67], a[112:115], v[208:211]
    ds_read_b64_tr_b16 v[162:163], v232 offset:512
    v_mfma_f32_16x16x32_bf16 v[208:211], a[80:83], a[96:99], v[208:211]
    ds_read_b64_tr_b16 v[164:165], v233 offset:0
    v_mfma_f32_16x16x32_bf16 v[212:215], a[68:71], a[112:115], v[212:215]
    ds_read_b64_tr_b16 v[166:167], v233 offset:512
    v_mfma_f32_16x16x32_bf16 v[212:215], a[80:83], a[100:103], v[212:215]
    ds_read_b64_tr_b16 v[168:169], v234 offset:0
    v_mfma_f32_16x16x32_bf16 v[216:219], a[72:75], a[112:115], v[216:219]
    ds_read_b64_tr_b16 v[170:171], v234 offset:512
    v_mfma_f32_16x16x32_bf16 v[216:219], a[80:83], a[104:107], v[216:219]
    ds_read_b64_tr_b16 v[172:173], v235 offset:0
    v_mfma_f32_16x16x32_bf16 v[220:223], a[76:79], a[112:115], v[220:223]
    ds_read_b64_tr_b16 v[174:175], v235 offset:512
    v_mfma_f32_16x16x32_bf16 v[220:223], a[80:83], a[108:111], v[220:223]
    s_lshl_b32 s26, s74, 6
    s_add_u32 m0, s22, 49152
    s_or_b32 s26, s26, s81
    buffer_load_dwordx4 v240, s[64:67], s26 offen offset:0 lds
    s_waitcnt lgkmcnt(15)
    v_mfma_f32_16x16x32_bf16 v[212:215], a[64:67], a[116:119], v[212:215]
    ds_read_b128 a[48:51], v251 offset:1664
    v_mfma_f32_16x16x32_bf16 v[212:215], a[84:87], a[96:99], v[212:215]
    ds_read_b64 a[20:21], v250 offset:2688
    v_mfma_f32_16x16x32_bf16 v[216:219], a[68:71], a[116:119], v[216:219]
    ds_read_b64 a[22:23], v250 offset:2696
    v_mfma_f32_16x16x32_bf16 v[216:219], a[84:87], a[100:103], v[216:219]
    ds_read_b128 a[52:55], v251 offset:1152
    v_mfma_f32_16x16x32_bf16 v[220:223], a[72:75], a[116:119], v[220:223]
    buffer_load_dwordx4 v241, s[64:67], s26 offen offset:1024 lds
    v_mfma_f32_16x16x32_bf16 v[220:223], a[84:87], a[104:107], v[220:223]
    ds_read_b64 a[24:25], v250 offset:3200
    v_mfma_f32_16x16x32_bf16 v[216:219], a[64:67], a[120:123], v[216:219]
    ds_read_b64 a[26:27], v250 offset:3208
    v_mfma_f32_16x16x32_bf16 v[216:219], a[88:91], a[96:99], v[216:219]
    buffer_load_dwordx4 v242, s[64:67], s26 offen offset:2048 lds
    v_mfma_f32_16x16x32_bf16 v[220:223], a[68:71], a[120:123], v[220:223]
    ds_read_b128 a[56:59], v251 offset:640
    v_mfma_f32_16x16x32_bf16 v[220:223], a[88:91], a[100:103], v[220:223]
    ds_read_b64 a[28:29], v250 offset:3712
    v_mfma_f32_16x16x32_bf16 v[220:223], a[64:67], a[124:127], v[220:223]
    buffer_load_dwordx4 v243, s[64:67], s26 offen offset:3072 lds
    v_mfma_f32_16x16x32_bf16 v[220:223], a[92:95], a[96:99], v[220:223]
    ds_read_b64 a[30:31], v250 offset:3720
    ds_read_b128 a[60:63], v251 offset:128
    v_mfma_f32_16x16x32_bf16 v[192:195], a[0:3], a[32:35], v[192:195]
    s_lshl_b32 s26, s75, 6
    s_add_u32 m0, s22, 65536
    s_or_b32 s26, s26, s81
    buffer_load_dwordx4 v240, s[64:67], s26 offen offset:0 lds
    v_mfma_f32_16x16x32_bf16 v[196:199], a[0:3], a[36:39], v[196:199]
    ds_read_b64 a[64:65], v250 offset:192
    v_mfma_f32_16x16x32_bf16 v[196:199], a[4:7], a[32:35], v[196:199]
    ds_read_b64 a[66:67], v250 offset:200
    v_mfma_f32_16x16x32_bf16 v[200:203], a[4:7], a[36:39], v[200:203]
    ds_read_b128 a[96:99], v251 offset:3776
    s_waitcnt lgkmcnt(15)
    v_mfma_f32_16x16x32_bf16 v[200:203], a[0:3], a[40:43], v[200:203]
    buffer_load_dwordx4 v241, s[64:67], s26 offen offset:1024 lds
    v_mfma_f32_16x16x32_bf16 v[200:203], a[8:11], a[32:35], v[200:203]
    ds_read_b64 a[68:69], v250 offset:704
    v_mfma_f32_16x16x32_bf16 v[204:207], a[4:7], a[40:43], v[204:207]
    ds_read_b64 a[70:71], v250 offset:712
    v_mfma_f32_16x16x32_bf16 v[204:207], a[8:11], a[36:39], v[204:207]
    ds_read_b128 a[100:103], v251 offset:3264
    v_mfma_f32_16x16x32_bf16 v[208:211], a[8:11], a[40:43], v[208:211]
    ds_read_b64 a[72:73], v250 offset:1216
    buffer_load_dwordx4 v242, s[64:67], s26 offen offset:2048 lds
    v_mfma_f32_16x16x32_bf16 v[204:207], a[0:3], a[44:47], v[204:207]
    ds_read_b64 a[74:75], v250 offset:1224
    v_mfma_f32_16x16x32_bf16 v[204:207], a[12:15], a[32:35], v[204:207]
    s_waitcnt vmcnt(15)
    ds_read_b64_tr_b16 v[176:177], v232 offset:16384
    v_mfma_f32_16x16x32_bf16 v[208:211], a[4:7], a[44:47], v[208:211]
    ds_read_b64_tr_b16 v[178:179], v232 offset:16896
    buffer_load_dwordx4 v243, s[64:67], s26 offen offset:3072 lds
    v_mfma_f32_16x16x32_bf16 v[208:211], a[12:15], a[36:39], v[208:211]
    ds_read_b64_tr_b16 v[180:181], v233 offset:16384
    v_mfma_f32_16x16x32_bf16 v[212:215], a[8:11], a[44:47], v[212:215]
    ds_read_b64_tr_b16 v[182:183], v233 offset:16896
    v_mfma_f32_16x16x32_bf16 v[212:215], a[12:15], a[40:43], v[212:215]
    ds_read_b64_tr_b16 v[184:185], v234 offset:16384
    v_mfma_f32_16x16x32_bf16 v[216:219], a[12:15], a[44:47], v[216:219]
    ds_read_b64_tr_b16 v[186:187], v234 offset:16896
    s_waitcnt lgkmcnt(15)
    v_mfma_f32_16x16x32_bf16 v[208:211], a[0:3], a[48:51], v[208:211]
    ds_read_b64_tr_b16 v[188:189], v235 offset:16384
    v_mfma_f32_16x16x32_bf16 v[208:211], a[16:19], a[32:35], v[208:211]
    ds_read_b64_tr_b16 v[190:191], v235 offset:16896
    v_mfma_f32_16x16x32_bf16 v[212:215], a[4:7], a[48:51], v[212:215]
    s_lshl_b32 s26, s76, 6
    s_add_u32 m0, s22, 81920
    s_or_b32 s26, s26, s81
    buffer_load_dwordx4 v240, s[64:67], s26 offen offset:0 lds
    v_mfma_f32_16x16x32_bf16 v[212:215], a[16:19], a[36:39], v[212:215]
    ds_read_b128 a[104:107], v251 offset:2752
    v_mfma_f32_16x16x32_bf16 v[216:219], a[8:11], a[48:51], v[216:219]
    buffer_load_dwordx4 v241, s[64:67], s26 offen offset:1024 lds
    v_mfma_f32_16x16x32_bf16 v[216:219], a[16:19], a[40:43], v[216:219]
    ds_read_b64 a[76:77], v250 offset:1728
    buffer_load_dwordx4 v242, s[64:67], s26 offen offset:2048 lds
    v_mfma_f32_16x16x32_bf16 v[220:223], a[12:15], a[48:51], v[220:223]
    ds_read_b64 a[78:79], v250 offset:1736
    v_mfma_f32_16x16x32_bf16 v[220:223], a[16:19], a[44:47], v[220:223]
    ds_read_b128 a[108:111], v251 offset:2240
    buffer_load_dwordx4 v243, s[64:67], s26 offen offset:3072 lds
    v_mfma_f32_16x16x32_bf16 v[212:215], a[0:3], a[52:55], v[212:215]
    ds_read_b64 a[80:81], v250 offset:2240
    v_mfma_f32_16x16x32_bf16 v[212:215], a[20:23], a[32:35], v[212:215]
    ds_read_b64 a[82:83], v250 offset:2248
    v_mfma_f32_16x16x32_bf16 v[216:219], a[4:7], a[52:55], v[216:219]
    ds_read_b128 a[112:115], v251 offset:1728
    v_mfma_f32_16x16x32_bf16 v[216:219], a[20:23], a[36:39], v[216:219]
    v_min_u32 v14, 6, v1
    v_lshlrev_b32 v14, 3, v14
    s_lshl_b32 s93, s8, 9
    s_lshl_b32 s92, s3, 6
    s_add_u32 s93, s93, s92
    s_add_u32 s93, s93, 12656640
    buffer_load_dwordx2 v[248:249], v14, s[52:55], s93 offen sc1
    v_mfma_f32_16x16x32_bf16 v[220:223], a[8:11], a[52:55], v[220:223]
    ds_read_b64 a[84:85], v250 offset:2752
    v_mfma_f32_16x16x32_bf16 v[220:223], a[20:23], a[40:43], v[220:223]
    ds_read_b64 a[86:87], v250 offset:2760
    v_mfma_f32_16x16x32_bf16 v[216:219], a[0:3], a[56:59], v[216:219]
    s_lshl_b32 s26, s77, 6
    s_add_u32 m0, s22, 0
    s_or_b32 s26, s26, s81
    buffer_load_dwordx4 v240, s[64:67], s26 offen offset:0 lds
    v_mfma_f32_16x16x32_bf16 v[216:219], a[24:27], a[32:35], v[216:219]
    ds_read_b128 a[116:119], v251 offset:1216
    v_mfma_f32_16x16x32_bf16 v[220:223], a[4:7], a[56:59], v[220:223]
    ds_read_b64 a[88:89], v250 offset:3264
    v_mfma_f32_16x16x32_bf16 v[220:223], a[24:27], a[36:39], v[220:223]
    buffer_load_dwordx4 v241, s[64:67], s26 offen offset:1024 lds
    s_waitcnt lgkmcnt(15)
    v_mfma_f32_16x16x32_bf16 v[220:223], a[0:3], a[60:63], v[220:223]
    ds_read_b64 a[90:91], v250 offset:3272
    v_mfma_f32_16x16x32_bf16 v[220:223], a[28:31], a[32:35], v[220:223]
    ds_read_b128 a[120:123], v251 offset:704
    ds_read_b64 a[92:93], v250 offset:3776
    ds_read_b64 a[94:95], v250 offset:3784
    ds_read_b128 a[124:127], v251 offset:192
    v_mfma_f32_16x16x32_bf16 v[192:195], a[64:67], a[96:99], v[192:195]
    buffer_load_dwordx4 v242, s[64:67], s26 offen offset:2048 lds
    v_mfma_f32_16x16x32_bf16 v[196:199], a[64:67], a[100:103], v[196:199]
    v_mfma_f32_16x16x32_bf16 v[196:199], a[68:71], a[96:99], v[196:199]
    buffer_load_dwordx4 v243, s[64:67], s26 offen offset:3072 lds
    v_mfma_f32_16x16x32_bf16 v[200:203], a[68:71], a[100:103], v[200:203]
    s_waitcnt lgkmcnt(15)
    v_mfma_f32_16x16x32_bf16 v[200:203], a[64:67], a[104:107], v[200:203]
    v_mfma_f32_16x16x32_bf16 v[200:203], a[72:75], a[96:99], v[200:203]
    v_mfma_f32_16x16x32_bf16 v[204:207], a[68:71], a[104:107], v[204:207]
    s_lshl_b32 s26, s78, 6
    s_add_u32 m0, s22, 16384
    s_or_b32 s26, s26, s81
    buffer_load_dwordx4 v240, s[64:67], s26 offen offset:0 lds
    v_mfma_f32_16x16x32_bf16 v[204:207], a[72:75], a[100:103], v[204:207]
    v_mfma_f32_16x16x32_bf16 v[208:211], a[72:75], a[104:107], v[208:211]
    s_waitcnt lgkmcnt(12)
    v_mfma_f32_16x16x32_bf16 v[204:207], a[64:67], a[108:111], v[204:207]
    v_mfma_f32_16x16x32_bf16 v[204:207], a[76:79], a[96:99], v[204:207]
    buffer_load_dwordx4 v241, s[64:67], s26 offen offset:1024 lds
    v_mfma_f32_16x16x32_bf16 v[208:211], a[68:71], a[108:111], v[208:211]
    v_mfma_f32_16x16x32_bf16 v[208:211], a[76:79], a[100:103], v[208:211]
    v_mfma_f32_16x16x32_bf16 v[212:215], a[72:75], a[108:111], v[212:215]
    v_mfma_f32_16x16x32_bf16 v[212:215], a[76:79], a[104:107], v[212:215]
    v_mfma_f32_16x16x32_bf16 v[216:219], a[76:79], a[108:111], v[216:219]
    s_waitcnt lgkmcnt(9)
    v_mfma_f32_16x16x32_bf16 v[208:211], a[64:67], a[112:115], v[208:211]
    v_mfma_f32_16x16x32_bf16 v[208:211], a[80:83], a[96:99], v[208:211]
    buffer_load_dwordx4 v242, s[64:67], s26 offen offset:2048 lds
    v_mfma_f32_16x16x32_bf16 v[212:215], a[68:71], a[112:115], v[212:215]
    v_mfma_f32_16x16x32_bf16 v[212:215], a[80:83], a[100:103], v[212:215]
    v_mfma_f32_16x16x32_bf16 v[216:219], a[72:75], a[112:115], v[216:219]
    buffer_load_dwordx4 v243, s[64:67], s26 offen offset:3072 lds
    v_mfma_f32_16x16x32_bf16 v[216:219], a[80:83], a[104:107], v[216:219]
    v_mfma_f32_16x16x32_bf16 v[220:223], a[76:79], a[112:115], v[220:223]
    v_mfma_f32_16x16x32_bf16 v[220:223], a[80:83], a[108:111], v[220:223]
    s_waitcnt lgkmcnt(6)
    v_mfma_f32_16x16x32_bf16 v[212:215], a[64:67], a[116:119], v[212:215]
    v_mfma_f32_16x16x32_bf16 v[212:215], a[84:87], a[96:99], v[212:215]
    v_mfma_f32_16x16x32_bf16 v[216:219], a[68:71], a[116:119], v[216:219]
    v_mfma_f32_16x16x32_bf16 v[216:219], a[84:87], a[100:103], v[216:219]
    v_mfma_f32_16x16x32_bf16 v[220:223], a[72:75], a[116:119], v[220:223]
    v_mfma_f32_16x16x32_bf16 v[220:223], a[84:87], a[104:107], v[220:223]
    s_waitcnt lgkmcnt(3)
    v_mfma_f32_16x16x32_bf16 v[216:219], a[64:67], a[120:123], v[216:219]
    v_mfma_f32_16x16x32_bf16 v[216:219], a[88:91], a[96:99], v[216:219]
    s_waitcnt vmcnt(8)
    v_cmp_ne_u64 vcc, s[88:89], v[248:249]
    s_cbranch_vccnz L_pl_14
L_pd_15:
    v_mfma_f32_16x16x32_bf16 v[220:223], a[68:71], a[120:123], v[220:223]
    s_add_u32 s72, s72, s82
    buffer_load_dwordx4 a[128:131], v244, s[52:55], s72 offen sc1
    v_mfma_f32_16x16x32_bf16 v[220:223], a[88:91], a[100:103], v[220:223]
    s_waitcnt lgkmcnt(0)
    v_mfma_f32_16x16x32_bf16 v[220:223], a[64:67], a[124:127], v[220:223]
    buffer_load_dwordx4 a[132:135], v245, s[52:55], s72 offen sc1
    v_mfma_f32_16x16x32_bf16 v[220:223], a[92:95], a[96:99], v[220:223]
    s_nop 7
    s_add_u32 s24, s22, 130560
    v_add_u32 v8, s24, v11
    buffer_load_dwordx4 a[136:139], v246, s[52:55], s72 offen sc1
    buffer_load_dwordx4 a[140:143], v247, s[52:55], s72 offen sc1
    s_xor_b32 s25, s22, 4096
    s_add_u32 s25, s25, 130560
    v_add_u32 v9, s25, v11
    v_lshlrev_b32 v5, 5, v3
    v_lshl_add_u32 v5, v4, 3, v5
    s_sub_u32 s24, s20, s36
    s_add_u32 s24, s24, 2552
    v_sub_u32 v6, s24, v5
    ds_read_b64 v[224:225], v6 offset:1536
    ds_read_b64 v[226:227], v6 offset:1024
    s_add_u32 s73, s73, s82
    buffer_load_dwordx4 a[144:147], v244, s[52:55], s73 offen sc1
    buffer_load_dwordx4 a[148:151], v245, s[52:55], s73 offen sc1
    ds_read_b64 v[228:229], v6 offset:512
    ds_read_b64 v[230:231], v6 offset:0
    s_barrier
    s_cmp_lg_u32 s33, 0
    s_cbranch_scc1 L_e1_16
    ds_write_b128 v8, v[208:211] offset:0
    ds_write_b128 v8, v[212:215] offset:1024
    ds_write_b128 v8, v[216:219] offset:2048
    ds_write_b128 v8, v[220:223] offset:3072
L_ej_17:
    buffer_load_dwordx4 a[152:155], v246, s[52:55], s73 offen sc1
    buffer_load_dwordx4 a[156:159], v247, s[52:55], s73 offen sc1
    s_lshl_b32 s24, s32, 4
    s_lshr_b32 s24, s39, s24
    s_lshl_b32 s19, s24, 16
    v_and_b32 v8, 1, v4
    s_add_u32 s74, s74, s82
    buffer_load_dwordx4 a[160:163], v244, s[52:55], s74 offen sc1
    buffer_load_dwordx4 a[164:167], v245, s[52:55], s74 offen sc1
    v_lshlrev_b32 v8, 9, v8
    v_lshrrev_b32 v7, 1, v4
    v_lshl_add_u32 v8, v7, 4, v8
    v_lshl_add_u32 v8, v3, 5, v8
    s_add_u32 s21, s37, 10485760
    s_waitcnt lgkmcnt(4)
    v_and_b32 v32, 0xffff0000, v225
    v_lshlrev_b32 v33, 16, v225
    v_and_b32 v34, 0xffff0000, v224
    v_lshlrev_b32 v35, 16, v224
    v_and_b32 v36, 0xffff0000, v227
    v_lshlrev_b32 v37, 16, v227
    v_and_b32 v38, 0xffff0000, v226
    v_lshlrev_b32 v39, 16, v226
    v_and_b32 v40, 0xffff0000, v229
    v_lshlrev_b32 v41, 16, v229
    v_and_b32 v42, 0xffff0000, v228
    v_lshlrev_b32 v43, 16, v228
    v_and_b32 v44, 0xffff0000, v231
    v_lshlrev_b32 v45, 16, v231
    v_and_b32 v46, 0xffff0000, v230
    v_lshlrev_b32 v47, 16, v230
    s_waitcnt lgkmcnt(0)
    s_barrier
    ds_read_b128 v[16:19], v9 offset:0
    ds_read_b128 v[20:23], v9 offset:1024
    ds_read_b128 v[24:27], v9 offset:2048
    ds_read_b128 v[28:31], v9 offset:3072
    s_mov_b32 s24, s19
    s_cmp_lg_u32 s33, 0
    s_cbranch_scc1 L_e1_18
    v_pk_fma_f32 v[48:49], v[32:33], s[24:25], v[192:193] op_sel_hi:[1,0,1]
    v_pk_fma_f32 v[50:51], v[34:35], s[24:25], v[194:195] op_sel_hi:[1,0,1]
    v_pk_fma_f32 v[52:53], v[36:37], s[24:25], v[196:197] op_sel_hi:[1,0,1]
    v_pk_fma_f32 v[54:55], v[38:39], s[24:25], v[198:199] op_sel_hi:[1,0,1]
    v_pk_fma_f32 v[56:57], v[40:41], s[24:25], v[200:201] op_sel_hi:[1,0,1]
    v_pk_fma_f32 v[58:59], v[42:43], s[24:25], v[202:203] op_sel_hi:[1,0,1]
    v_pk_fma_f32 v[60:61], v[44:45], s[24:25], v[204:205] op_sel_hi:[1,0,1]
    v_pk_fma_f32 v[62:63], v[46:47], s[24:25], v[206:207] op_sel_hi:[1,0,1]
L_ej_19:
    s_waitcnt lgkmcnt(3)
    buffer_load_dwordx4 a[168:171], v246, s[52:55], s74 offen sc1
    buffer_load_dwordx4 a[172:175], v247, s[52:55], s74 offen sc1
    v_pk_add_f32 v[48:49], v[48:49], v[16:17]
    v_pk_add_f32 v[50:51], v[50:51], v[18:19]
    v_cvt_pk_bf16_f32 v192, v48, v49
    v_cvt_pk_bf16_f32 v193, v50, v51
    s_waitcnt lgkmcnt(2)
    v_pk_add_f32 v[52:53], v[52:53], v[20:21]
    v_pk_add_f32 v[54:55], v[54:55], v[22:23]
    v_cvt_pk_bf16_f32 v194, v52, v53
    v_cvt_pk_bf16_f32 v195, v54, v55
    s_nop 1
    v_permlane16_swap_b32 v192, v194
    v_permlane16_swap_b32 v193, v195
    buffer_store_dwordx4 v[192:195], v8, s[52:55], s21 offen offset:0 sc1
    s_waitcnt lgkmcnt(1)
    v_pk_add_f32 v[56:57], v[56:57], v[24:25]
    v_pk_add_f32 v[58:59], v[58:59], v[26:27]
    v_cvt_pk_bf16_f32 v200, v56, v57
    v_cvt_pk_bf16_f32 v201, v58, v59
    s_waitcnt lgkmcnt(0)
    v_pk_add_f32 v[60:61], v[60:61], v[28:29]
    v_pk_add_f32 v[62:63], v[62:63], v[30:31]
    v_cvt_pk_bf16_f32 v202, v60, v61
    v_cvt_pk_bf16_f32 v203, v62, v63
    s_nop 1
    v_permlane16_swap_b32 v200, v202
    v_permlane16_swap_b32 v201, v203
    buffer_store_dwordx4 v[200:203], v8, s[52:55], s21 offen offset:1024 sc1
    s_waitcnt vmcnt(10)
    v_mfma_f32_16x16x32_bf16 v[16:19], v[80:83], a[128:131], 0
    s_add_u32 s75, s75, s82
    buffer_load_dwordx4 a[176:179], v244, s[52:55], s75 offen sc1
    v_mfma_f32_16x16x32_bf16 v[20:23], v[80:83], a[132:135], 0
    ds_read_b64_tr_b16 a[240:241], v236 offset:32768
    v_mfma_f32_16x16x32_bf16 v[24:27], v[80:83], a[136:139], 0
    ds_read_b64_tr_b16 a[242:243], v236 offset:33280
    v_mfma_f32_16x16x32_bf16 v[28:31], v[80:83], a[140:143], 0
    buffer_load_dwordx4 a[180:183], v245, s[52:55], s75 offen sc1
    v_mfma_f32_16x16x32_bf16 v[32:35], v[84:87], a[128:131], 0
    ds_read_b64_tr_b16 a[244:245], v237 offset:32768
    v_mfma_f32_16x16x32_bf16 v[36:39], v[84:87], a[132:135], 0
    ds_read_b64_tr_b16 a[246:247], v237 offset:33280
    v_mfma_f32_16x16x32_bf16 v[40:43], v[84:87], a[136:139], 0
    buffer_load_dwordx4 a[184:187], v246, s[52:55], s75 offen sc1
    v_mfma_f32_16x16x32_bf16 v[44:47], v[84:87], a[140:143], 0
    ds_read_b64_tr_b16 a[248:249], v238 offset:32768
    v_mfma_f32_16x16x32_bf16 v[48:51], v[88:91], a[128:131], 0
    ds_read_b64_tr_b16 a[250:251], v238 offset:33280
    v_mfma_f32_16x16x32_bf16 v[52:55], v[88:91], a[132:135], 0
    buffer_load_dwordx4 a[188:191], v247, s[52:55], s75 offen sc1
    v_mfma_f32_16x16x32_bf16 v[56:59], v[88:91], a[136:139], 0
    ds_read_b64_tr_b16 a[252:253], v239 offset:32768
    v_mfma_f32_16x16x32_bf16 v[60:63], v[88:91], a[140:143], 0
    v_min_u32 v14, 6, v1
    v_lshlrev_b32 v14, 3, v14
    s_lshl_b32 s93, s8, 9
    s_lshl_b32 s92, s3, 6
    s_add_u32 s93, s93, s92
    s_add_u32 s93, s93, 12656896
    buffer_load_dwordx2 v[248:249], v14, s[52:55], s93 offen sc1
    v_mfma_f32_16x16x32_bf16 v[64:67], v[92:95], a[128:131], 0
    ds_read_b64_tr_b16 a[254:255], v239 offset:33280
    v_mfma_f32_16x16x32_bf16 v[68:71], v[92:95], a[132:135], 0
    v_mfma_f32_16x16x32_bf16 v[72:75], v[92:95], a[136:139], 0
    s_add_u32 s76, s76, s82
    buffer_load_dwordx4 a[192:195], v244, s[52:55], s76 offen sc1
    v_mfma_f32_16x16x32_bf16 v[76:79], v[92:95], a[140:143], 0
    s_waitcnt vmcnt(12)
    v_mfma_f32_16x16x32_bf16 v[16:19], v[96:99], a[144:147], v[16:19]
    ds_read_b64_tr_b16 a[224:225], v232 offset:32768
    v_mfma_f32_16x16x32_bf16 v[20:23], v[96:99], a[148:151], v[20:23]
    buffer_load_dwordx4 a[196:199], v245, s[52:55], s76 offen sc1
    v_mfma_f32_16x16x32_bf16 v[24:27], v[96:99], a[152:155], v[24:27]
    ds_read_b64_tr_b16 a[226:227], v232 offset:33280
    v_mfma_f32_16x16x32_bf16 v[28:31], v[96:99], a[156:159], v[28:31]
    ds_read_b64_tr_b16 a[228:229], v233 offset:32768
    v_mfma_f32_16x16x32_bf16 v[32:35], v[100:103], a[144:147], v[32:35]
    ds_read_b64_tr_b16 a[230:231], v233 offset:33280
    v_mfma_f32_16x16x32_bf16 v[36:39], v[100:103], a[148:151], v[36:39]
    ds_read_b64_tr_b16 a[232:233], v234 offset:32768
    v_mfma_f32_16x16x32_bf16 v[40:43], v[100:103], a[152:155], v[40:43]
    ds_read_b64_tr_b16 a[234:235], v234 offset:33280
    v_mfma_f32_16x16x32_bf16 v[44:47], v[100:103], a[156:159], v[44:47]
    buffer_load_dwordx4 a[200:203], v246, s[52:55], s76 offen sc1
    v_mfma_f32_16x16x32_bf16 v[48:51], v[104:107], a[144:147], v[48:51]
    ds_read_b64_tr_b16 a[236:237], v235 offset:32768
    v_mfma_f32_16x16x32_bf16 v[52:55], v[104:107], a[148:151], v[52:55]
    ds_read_b64_tr_b16 a[238:239], v235 offset:33280
    v_mfma_f32_16x16x32_bf16 v[56:59], v[104:107], a[152:155], v[56:59]
    buffer_load_dwordx4 a[204:207], v247, s[52:55], s76 offen sc1
    v_mfma_f32_16x16x32_bf16 v[60:63], v[104:107], a[156:159], v[60:63]
    v_mfma_f32_16x16x32_bf16 v[64:67], v[108:111], a[144:147], v[64:67]
    v_mfma_f32_16x16x32_bf16 v[68:71], v[108:111], a[148:151], v[68:71]
    v_mfma_f32_16x16x32_bf16 v[72:75], v[108:111], a[152:155], v[72:75]
    v_mfma_f32_16x16x32_bf16 v[76:79], v[108:111], a[156:159], v[76:79]
    s_waitcnt vmcnt(11)
    v_mfma_f32_16x16x32_bf16 v[16:19], v[112:115], a[160:163], v[16:19]
    ds_read_b64_tr_b16 a[128:129], v232 offset:49152
    v_mfma_f32_16x16x32_bf16 v[20:23], v[112:115], a[164:167], v[20:23]
    ds_read_b64_tr_b16 a[130:131], v232 offset:49664
    v_mfma_f32_16x16x32_bf16 v[24:27], v[112:115], a[168:171], v[24:27]
    ds_read_b64_tr_b16 a[132:133], v233 offset:49152
    v_mfma_f32_16x16x32_bf16 v[28:31], v[112:115], a[172:175], v[28:31]
    ds_read_b64_tr_b16 a[134:135], v233 offset:49664
    v_mfma_f32_16x16x32_bf16 v[32:35], v[116:119], a[160:163], v[32:35]
    ds_read_b64_tr_b16 a[136:137], v234 offset:49152
    v_mfma_f32_16x16x32_bf16 v[36:39], v[116:119], a[164:167], v[36:39]
    ds_read_b64_tr_b16 a[138:139], v234 offset:49664
    v_mfma_f32_16x16x32_bf16 v[40:43], v[116:119], a[168:171], v[40:43]
    ds_read_b64_tr_b16 a[140:141], v235 offset:49152
    v_mfma_f32_16x16x32_bf16 v[44:47], v[116:119], a[172:175], v[44:47]
    ds_read_b64_tr_b16 a[142:143], v235 offset:49664
    v_mfma_f32_16x16x32_bf16 v[48:51], v[120:123], a[160:163], v[48:51]
    v_mfma_f32_16x16x32_bf16 v[52:55], v[120:123], a[164:167], v[52:55]
    v_mfma_f32_16x16x32_bf16 v[56:59], v[120:123], a[168:171], v[56:59]
    v_mfma_f32_16x16x32_bf16 v[60:63], v[120:123], a[172:175], v[60:63]
    v_mfma_f32_16x16x32_bf16 v[64:67], v[124:127], a[160:163], v[64:67]
    v_mfma_f32_16x16x32_bf16 v[68:71], v[124:127], a[164:167], v[68:71]
    v_mfma_f32_16x16x32_bf16 v[72:75], v[124:127], a[168:171], v[72:75]
    v_mfma_f32_16x16x32_bf16 v[76:79], v[124:127], a[172:175], v[76:79]
    s_add_u32 s77, s77, s82
    buffer_load_dwordx4 a[208:211], v244, s[52:55], s77 offen sc1
    buffer_load_dwordx4 a[212:215], v245, s[52:55], s77 offen sc1
    buffer_load_dwordx4 a[216:219], v246, s[52:55], s77 offen sc1
    buffer_load_dwordx4 a[220:223], v247, s[52:55], s77 offen sc1
    s_add_u32 s78, s78, s82
    buffer_load_dwordx4 a[0:3], v244, s[52:55], s78 offen sc1
    s_waitcnt vmcnt(10)
    v_mfma_f32_16x16x32_bf16 v[16:19], v[128:131], a[176:179], v[16:19]
    s_lshl_b32 s92, s4, 1
    s_add_u32 s92, s92, s33
    s_lshl_b32 s92, s92, 6
    s_lshl_b32 s24, s5, 1
    s_add_u32 s92, s92, s24
    s_add_u32 s92, s92, s32
    s_lshl_b32 s92, s92, 7
    s_add_u32 s92, s92, 12681216
    s_mov_b64 exec, 1
    buffer_store_dwordx2 v[12:13], v10, s[52:55], s92 offen sc1
    s_mov_b64 exec, -1
    v_mfma_f32_16x16x32_bf16 v[20:23], v[128:131], a[180:183], v[20:23]
    ds_read_b64_tr_b16 a[144:145], v236 offset:0
    v_mfma_f32_16x16x32_bf16 v[24:27], v[128:131], a[184:187], v[24:27]
    ds_read_b64_tr_b16 a[146:147], v236 offset:512
    buffer_load_dwordx4 a[4:7], v245, s[52:55], s78 offen sc1
    v_mfma_f32_16x16x32_bf16 v[28:31], v[128:131], a[188:191], v[28:31]
    ds_read_b64_tr_b16 a[148:149], v237 offset:0
    v_mfma_f32_16x16x32_bf16 v[32:35], v[132:135], a[176:179], v[32:35]
    ds_read_b64_tr_b16 a[150:151], v237 offset:512
    v_mfma_f32_16x16x32_bf16 v[36:39], v[132:135], a[180:183], v[36:39]
    buffer_load_dwordx4 a[8:11], v246, s[52:55], s78 offen sc1
    v_mfma_f32_16x16x32_bf16 v[40:43], v[132:135], a[184:187], v[40:43]
    ds_read_b64_tr_b16 a[152:153], v238 offset:0
    v_mfma_f32_16x16x32_bf16 v[44:47], v[132:135], a[188:191], v[44:47]
    ds_read_b64_tr_b16 a[154:155], v238 offset:512
    v_mfma_f32_16x16x32_bf16 v[48:51], v[136:139], a[176:179], v[48:51]
    ds_read_b64_tr_b16 a[156:157], v239 offset:0
    buffer_load_dwordx4 a[12:15], v247, s[52:55], s78 offen sc1
    v_mfma_f32_16x16x32_bf16 v[52:55], v[136:139], a[180:183], v[52:55]
    s_waitcnt vmcnt(12)
    v_cmp_ne_u64 vcc, s[88:89], v[248:249]
    s_cbranch_vccnz L_pl_20
L_pd_21:
    v_mfma_f32_16x16x32_bf16 v[56:59], v[136:139], a[184:187], v[56:59]
    ds_read_b64_tr_b16 a[158:159], v239 offset:512
    v_mfma_f32_16x16x32_bf16 v[60:63], v[136:139], a[188:191], v[60:63]
    s_add_u32 s72, s72, s83
    buffer_load_dwordx4 a[16:19], v244, s[52:55], s72 offen sc1
    v_mfma_f32_16x16x32_bf16 v[64:67], v[140:143], a[176:179], v[64:67]
    v_mfma_f32_16x16x32_bf16 v[68:71], v[140:143], a[180:183], v[68:71]
    v_mfma_f32_16x16x32_bf16 v[72:75], v[140:143], a[184:187], v[72:75]
    v_mfma_f32_16x16x32_bf16 v[76:79], v[140:143], a[188:191], v[76:79]
    buffer_load_dwordx4 a[20:23], v245, s[52:55], s72 offen sc1
    s_waitcnt vmcnt(10)
    v_mfma_f32_16x16x32_bf16 v[16:19], v[144:147], a[192:195], v[16:19]
    s_barrier
    ds_read_b64_tr_b16 a[160:161], v236 offset:16384
    s_add_u32 s26, s3, 1
    v_mfma_f32_16x16x32_bf16 v[20:23], v[144:147], a[196:199], v[20:23]
    s_and_b32 s26, s26, 3
    ds_read_b64_tr_b16 a[162:163], v236 offset:16896
    buffer_load_dwordx4 a[24:27], v246, s[52:55], s72 offen sc1
    v_mfma_f32_16x16x32_bf16 v[24:27], v[144:147], a[200:203], v[24:27]
    s_mul_i32 s26, s26, 12288
    ds_read_b64_tr_b16 a[164:165], v237 offset:16384
    s_add_u32 s26, s26, 114688
    v_mfma_f32_16x16x32_bf16 v[28:31], v[144:147], a[204:207], v[28:31]
    ds_read_b64_tr_b16 a[166:167], v237 offset:16896
    v_add_u32 v192, s26, v11
    v_mfma_f32_16x16x32_bf16 v[32:35], v[148:151], a[192:195], v[32:35]
    s_add_u32 s26, s3, 2
    ds_read_b64_tr_b16 a[168:169], v238 offset:16384
    buffer_load_dwordx4 a[28:31], v247, s[52:55], s72 offen sc1
    v_mfma_f32_16x16x32_bf16 v[36:39], v[148:151], a[196:199], v[36:39]
    s_and_b32 s26, s26, 3
    ds_read_b64_tr_b16 a[170:171], v238 offset:16896
    s_mul_i32 s26, s26, 12288
    v_mfma_f32_16x16x32_bf16 v[40:43], v[148:151], a[200:203], v[40:43]
    s_add_u32 s26, s26, 118784
    ds_read_b64_tr_b16 a[172:173], v239 offset:16384
    v_add_u32 v193, s26, v11
    v_mfma_f32_16x16x32_bf16 v[44:47], v[148:151], a[204:207], v[44:47]
    s_add_u32 s26, s3, 3
    s_add_u32 s73, s73, s83
    buffer_load_dwordx4 a[36:39], v245, s[52:55], s73 offen sc1
    v_mfma_f32_16x16x32_bf16 v[48:51], v[152:155], a[192:195], v[48:51]
    s_and_b32 s26, s26, 3
    ds_read_b64_tr_b16 a[174:175], v239 offset:16896
    s_mul_i32 s26, s26, 12288
    v_mfma_f32_16x16x32_bf16 v[52:55], v[152:155], a[196:199], v[52:55]
    s_add_u32 s26, s26, 122880
    v_add_u32 v194, s26, v11
    v_lshlrev_b32 v195, 7, v3
    v_mfma_f32_16x16x32_bf16 v[56:59], v[152:155], a[200:203], v[56:59]
    v_lshl_add_u32 v195, v4, 3, v195
    s_mul_i32 s26, s3, 12288
    v_mfma_f32_16x16x32_bf16 v[60:63], v[152:155], a[204:207], v[60:63]
    s_add_u32 s26, s26, 122880
    s_add_u32 s74, s74, s83
    buffer_load_dwordx4 a[52:55], v245, s[52:55], s74 offen sc1
    v_mfma_f32_16x16x32_bf16 v[64:67], v[156:159], a[192:195], v[64:67]
    v_add_u32 v195, s26, v195
    v_lshrrev_b32 v196, 2, v1
    v_mfma_f32_16x16x32_bf16 v[68:71], v[156:159], a[196:199], v[68:71]
    v_lshlrev_b32 v196, 7, v196
    v_and_b32 v199, 3, v1
    v_mfma_f32_16x16x32_bf16 v[72:75], v[156:159], a[200:203], v[72:75]
    s_add_u32 s75, s75, s83
    buffer_load_dwordx4 a[68:71], v245, s[52:55], s75 offen sc1
    v_lshl_add_u32 v196, v199, 3, v196
    v_mfma_f32_16x16x32_bf16 v[76:79], v[156:159], a[204:207], v[76:79]
    s_lshl_b32 s26, s3, 5
    s_add_u32 s26, s26, 100352
    v_add_u32 v196, s26, v196
    s_waitcnt vmcnt(11)
    v_mfma_f32_16x16x32_bf16 v[16:19], v[160:163], a[208:211], v[16:19]
    s_mul_i32 s26, s3, 12288
    ds_read_b64_tr_b16 a[176:177], v232 offset:0
    s_add_u32 s26, s26, 114688
    v_mfma_f32_16x16x32_bf16 v[20:23], v[160:163], a[212:215], v[20:23]
    ds_read_b64_tr_b16 a[178:179], v232 offset:512
    v_add_u32 v197, s26, v11
    v_mfma_f32_16x16x32_bf16 v[24:27], v[160:163], a[216:219], v[24:27]
    ds_read_b64_tr_b16 a[180:181], v233 offset:0
    v_and_b32 v199, 1, v4
    v_mfma_f32_16x16x32_bf16 v[28:31], v[160:163], a[220:223], v[28:31]
    ds_read_b64_tr_b16 a[182:183], v233 offset:512
    v_lshrrev_b32 v198, 1, v4
    v_mfma_f32_16x16x32_bf16 v[32:35], v[164:167], a[208:211], v[32:35]
    ds_read_b64_tr_b16 a[184:185], v234 offset:0
    s_add_u32 s76, s76, s83
    buffer_load_dwordx4 a[84:87], v245, s[52:55], s76 offen sc1
    v_mfma_f32_16x16x32_bf16 v[36:39], v[164:167], a[212:215], v[36:39]
    ds_read_b64_tr_b16 a[186:187], v234 offset:512
    v_lshlrev_b32 v198, 4, v198
    v_mfma_f32_16x16x32_bf16 v[40:43], v[164:167], a[216:219], v[40:43]
    ds_read_b64_tr_b16 a[188:189], v235 offset:0
    v_lshl_add_u32 v198, v199, 5, v198
    v_mfma_f32_16x16x32_bf16 v[44:47], v[164:167], a[220:223], v[44:47]
    ds_read_b64_tr_b16 a[190:191], v235 offset:512
    s_add_u32 s77, s77, s83
    buffer_load_dwordx4 a[100:103], v245, s[52:55], s77 offen sc1
    v_mfma_f32_16x16x32_bf16 v[48:51], v[168:171], a[208:211], v[48:51]
    v_lshrrev_b32 v5, 3, v1
    v_and_b32 v6, 7, v1
    v_lshlrev_b32 v7, 12, v5
    v_lshl_add_u32 v7, v6, 4, v7
    v_lshlrev_b32 v5, 10, v5
    v_lshl_add_u32 v5, v6, 4, v5
    v_lshlrev_b32 v6, 3, v3
    v_mfma_f32_16x16x32_bf16 v[52:55], v[168:171], a[212:215], v[52:55]
    s_lshl_b32 s24, s9, 6
    s_add_u32 s78, s78, s83
    buffer_load_dwordx4 a[116:119], v245, s[52:55], s78 offen sc1
    v_mfma_f32_16x16x32_bf16 v[56:59], v[168:171], a[216:219], v[56:59]
    s_lshl_b32 s25, s3, 4
    s_add_u32 s24, s24, s25
    s_lshl_b32 s24, s24, 12
    v_mfma_f32_16x16x32_bf16 v[60:63], v[168:171], a[220:223], v[60:63]
    s_lshl_b32 s31, s8, 7
    s_add_u32 s24, s24, s31
    s_add_u32 s19, s24, 10485760
    v_mfma_f32_16x16x32_bf16 v[64:67], v[172:175], a[208:211], v[64:67]
    s_add_u32 s21, s19, 31744
    s_lshl_b32 s31, s8, 6
    buffer_load_dwordx4 a[40:43], v246, s[52:55], s73 offen sc1
    v_mfma_f32_16x16x32_bf16 v[68:71], v[172:175], a[212:215], v[68:71]
    s_add_u32 s31, s31, s25
    s_lshl_b32 s38, s31, 3
    s_add_u32 s38, s38, 12582912
    v_mfma_f32_16x16x32_bf16 v[72:75], v[172:175], a[216:219], v[72:75]
    s_lshl_b32 s24, s31, 10
    s_lshl_b32 s25, s9, 7
    s_add_u32 s31, s24, s25
    v_mfma_f32_16x16x32_bf16 v[76:79], v[172:175], a[220:223], v[76:79]
    s_add_u32 s34, s31, 7168
    v_lshl_add_u32 v198, v3, 10, v198
    s_lshl_b32 s27, s5, 2
    s_waitcnt vmcnt(11)
    v_mfma_f32_16x16x32_bf16 v[16:19], v[176:179], a[0:3], v[16:19]
    s_add_u32 s27, s27, s3
    ds_read_b64_tr_b16 a[192:193], v232 offset:16384
    v_mfma_f32_16x16x32_bf16 v[20:23], v[176:179], a[4:7], v[20:23]
    s_mul_i32 s24, s3, 12288
    s_add_u32 m0, s24, 122880
    s_nop 0
    buffer_load_dwordx4 v5, s[44:47], s31 offen lds
    v_mfma_f32_16x16x32_bf16 v[24:27], v[176:179], a[8:11], v[24:27]
    ds_read_b64_tr_b16 a[194:195], v232 offset:16896
    v_mfma_f32_16x16x32_bf16 v[28:31], v[176:179], a[12:15], v[28:31]
    ds_read_b64_tr_b16 a[196:197], v233 offset:16384
    v_mfma_f32_16x16x32_bf16 v[32:35], v[180:183], a[0:3], v[32:35]
    ds_read_b64_tr_b16 a[198:199], v233 offset:16896
    v_mfma_f32_16x16x32_bf16 v[36:39], v[180:183], a[4:7], v[36:39]
    buffer_load_dwordx4 v5, s[44:47], s34 offen offset:1024 lds
    v_mfma_f32_16x16x32_bf16 v[40:43], v[180:183], a[8:11], v[40:43]
    ds_read_b64_tr_b16 a[200:201], v234 offset:16384
    v_mfma_f32_16x16x32_bf16 v[44:47], v[180:183], a[12:15], v[44:47]
    ds_read_b64_tr_b16 a[202:203], v234 offset:16896
    v_mfma_f32_16x16x32_bf16 v[48:51], v[184:187], a[0:3], v[48:51]
    ds_read_b64_tr_b16 a[204:205], v235 offset:16384
    v_mfma_f32_16x16x32_bf16 v[52:55], v[184:187], a[4:7], v[52:55]
    ds_read_b64_tr_b16 a[206:207], v235 offset:16896
    buffer_load_dwordx2 v[82:83], v6, s[52:55], s38 offen sc1
    v_mfma_f32_16x16x32_bf16 v[56:59], v[184:187], a[8:11], v[56:59]
    v_mfma_f32_16x16x32_bf16 v[60:63], v[184:187], a[12:15], v[60:63]
    v_mfma_f32_16x16x32_bf16 v[64:67], v[188:191], a[0:3], v[64:67]
    v_mfma_f32_16x16x32_bf16 v[68:71], v[188:191], a[4:7], v[68:71]
    v_mfma_f32_16x16x32_bf16 v[72:75], v[188:191], a[8:11], v[72:75]
    buffer_load_dwordx4 a[56:59], v246, s[52:55], s74 offen sc1
    v_mfma_f32_16x16x32_bf16 v[76:79], v[188:191], a[12:15], v[76:79]
    s_waitcnt vmcnt(11) lgkmcnt(15)
    v_mfma_f32_16x16x32_bf16 v[16:19], a[240:243], a[16:19], v[16:19]
    v_mfma_f32_16x16x32_bf16 v[20:23], a[240:243], a[20:23], v[20:23]
    buffer_load_dwordx4 a[72:75], v246, s[52:55], s75 offen sc1
    v_mfma_f32_16x16x32_bf16 v[24:27], a[240:243], a[24:27], v[24:27]
    v_mfma_f32_16x16x32_bf16 v[28:31], a[240:243], a[28:31], v[28:31]
    v_mfma_f32_16x16x32_bf16 v[32:35], a[244:247], a[16:19], v[32:35]
    v_mfma_f32_16x16x32_bf16 v[36:39], a[244:247], a[20:23], v[36:39]
    buffer_load_dwordx4 a[88:91], v246, s[52:55], s76 offen sc1
    v_mfma_f32_16x16x32_bf16 v[40:43], a[244:247], a[24:27], v[40:43]
    v_mfma_f32_16x16x32_bf16 v[44:47], a[244:247], a[28:31], v[44:47]
    v_mfma_f32_16x16x32_bf16 v[48:51], a[248:251], a[16:19], v[48:51]
    buffer_load_dwordx4 a[104:107], v246, s[52:55], s77 offen sc1
    v_mfma_f32_16x16x32_bf16 v[52:55], a[248:251], a[20:23], v[52:55]
    v_mfma_f32_16x16x32_bf16 v[56:59], a[248:251], a[24:27], v[56:59]
    v_mfma_f32_16x16x32_bf16 v[60:63], a[248:251], a[28:31], v[60:63]
    buffer_load_dwordx4 a[120:123], v246, s[52:55], s78 offen sc1
    v_mfma_f32_16x16x32_bf16 v[64:67], a[252:255], a[16:19], v[64:67]
    v_mfma_f32_16x16x32_bf16 v[68:71], a[252:255], a[20:23], v[68:71]
    v_mfma_f32_16x16x32_bf16 v[72:75], a[252:255], a[24:27], v[72:75]
    buffer_load_dwordx4 a[44:47], v247, s[52:55], s73 offen sc1
    v_mfma_f32_16x16x32_bf16 v[76:79], a[252:255], a[28:31], v[76:79]
    s_waitcnt vmcnt(15)
    v_mfma_f32_16x16x32_bf16 v[20:23], a[224:227], a[36:39], v[20:23]
    v_lshrrev_b32 v14, 2, v1
    v_lshlrev_b32 v14, 7, v14
    s_lshl_b32 s93, s9, 1
    s_lshr_b32 s24, s8, 4
    s_add_u32 s93, s93, s24
    s_lshl_b32 s93, s93, 2
    s_add_u32 s93, s93, s3
    s_lshl_b32 s93, s93, 11
    s_add_u32 s93, s93, 12681216
    buffer_load_dwordx2 v[248:249], v14, s[52:55], s93 offen sc1
    v_mfma_f32_16x16x32_bf16 v[36:39], a[228:231], a[36:39], v[36:39]
    v_mfma_f32_16x16x32_bf16 v[52:55], a[232:235], a[36:39], v[52:55]
    buffer_load_dwordx4 a[60:63], v247, s[52:55], s74 offen sc1
    v_mfma_f32_16x16x32_bf16 v[68:71], a[236:239], a[36:39], v[68:71]
    s_waitcnt vmcnt(16)
    v_mfma_f32_16x16x32_bf16 v[20:23], a[128:131], a[52:55], v[20:23]
    v_mfma_f32_16x16x32_bf16 v[36:39], a[132:135], a[52:55], v[36:39]
    v_mfma_f32_16x16x32_bf16 v[52:55], a[136:139], a[52:55], v[52:55]
    v_mfma_f32_16x16x32_bf16 v[68:71], a[140:143], a[52:55], v[68:71]
    buffer_load_dwordx4 a[76:79], v247, s[52:55], s75 offen sc1
    s_waitcnt vmcnt(16)
    v_mfma_f32_16x16x32_bf16 v[20:23], a[144:147], a[68:71], v[20:23]
    v_mfma_f32_16x16x32_bf16 v[36:39], a[148:151], a[68:71], v[36:39]
    v_mfma_f32_16x16x32_bf16 v[52:55], a[152:155], a[68:71], v[52:55]
    v_mfma_f32_16x16x32_bf16 v[68:71], a[156:159], a[68:71], v[68:71]
    buffer_load_dwordx4 a[92:95], v247, s[52:55], s76 offen sc1
    s_waitcnt vmcnt(11)
    v_mfma_f32_16x16x32_bf16 v[20:23], a[160:163], a[84:87], v[20:23]
    ds_read_b64 v[84:85], v195 offset:0
    v_mfma_f32_16x16x32_bf16 v[36:39], a[164:167], a[84:87], v[36:39]
    ds_read_b64 v[86:87], v195 offset:32
    v_mfma_f32_16x16x32_bf16 v[52:55], a[168:171], a[84:87], v[52:55]
    ds_read_b64 v[88:89], v195 offset:64
    v_mfma_f32_16x16x32_bf16 v[68:71], a[172:175], a[84:87], v[68:71]
    ds_read_b64 v[90:91], v195 offset:96
    s_waitcnt lgkmcnt(12)
    v_mfma_f32_16x16x32_bf16 v[20:23], a[176:179], a[100:103], v[20:23]
    buffer_load_dwordx4 a[108:111], v247, s[52:55], s77 offen sc1
    v_mfma_f32_16x16x32_bf16 v[36:39], a[180:183], a[100:103], v[36:39]
    s_waitcnt vmcnt(11)
    v_cmp_ne_u32 vcc, s88, v83
    s_cbranch_vccnz L_gp_22
L_gd_23:
    v_mfma_f32_16x16x32_bf16 v[52:55], a[184:187], a[100:103], v[52:55]
    v_sub_f32 v80, 1.0, v82
    v_cvt_pk_bf16_f32 v80, v80, v80
    v_mfma_f32_16x16x32_bf16 v[68:71], a[188:191], a[100:103], v[68:71]
    buffer_load_dwordx4 a[124:127], v247, s[52:55], s78 offen sc1
    v_lshlrev_b32 v80, 16, v80
    s_waitcnt lgkmcnt(4)
    v_mfma_f32_16x16x32_bf16 v[20:23], a[192:195], a[116:119], v[20:23]
    v_mfma_f32_16x16x32_bf16 v[36:39], a[196:199], a[116:119], v[36:39]
    v_mfma_f32_16x16x32_bf16 v[52:55], a[200:203], a[116:119], v[52:55]
    s_waitcnt lgkmcnt(0)
    buffer_load_dwordx4 a[32:35], v244, s[52:55], s73 offen sc1
    v_lshlrev_b32 v100, 16, v84
    v_mfma_f32_16x16x32_bf16 v[68:71], a[204:207], a[116:119], v[68:71]
    v_and_b32 v101, 0xffff0000, v84
    v_lshlrev_b32 v102, 16, v85
    v_mfma_f32_16x16x32_bf16 v[24:27], a[224:227], a[40:43], v[24:27]
    v_and_b32 v103, 0xffff0000, v85
    v_mul_f32 v100, v100, v82
    v_mfma_f32_16x16x32_bf16 v[40:43], a[228:231], a[40:43], v[40:43]
    buffer_load_dwordx4 a[48:51], v244, s[52:55], s74 offen sc1
    v_mul_f32 v101, v101, v82
    s_waitcnt vmcnt(13)
    v_mfma_f32_16x16x32_bf16 v[24:27], a[128:131], a[56:59], v[24:27]
    ds_write_b128 v192, v[20:23] offset:0
    v_mfma_f32_16x16x32_bf16 v[40:43], a[132:135], a[56:59], v[40:43]
    buffer_load_dwordx4 a[64:67], v244, s[52:55], s75 offen sc1
    v_mul_f32 v102, v102, v82
    s_waitcnt vmcnt(13)
    v_mfma_f32_16x16x32_bf16 v[24:27], a[144:147], a[72:75], v[24:27]
    v_mul_f32 v103, v103, v82
    v_lshlrev_b32 v104, 16, v86
    v_mfma_f32_16x16x32_bf16 v[40:43], a[148:151], a[72:75], v[40:43]
    ds_write_b128 v192, v[36:39] offset:1024
    buffer_load_dwordx4 a[80:83], v244, s[52:55], s76 offen sc1
    s_waitcnt vmcnt(13)
    v_mfma_f32_16x16x32_bf16 v[24:27], a[160:163], a[88:91], v[24:27]
    v_and_b32 v105, 0xffff0000, v86
    v_lshlrev_b32 v106, 16, v87
    v_mfma_f32_16x16x32_bf16 v[40:43], a[164:167], a[88:91], v[40:43]
    v_and_b32 v107, 0xffff0000, v87
    v_mul_f32 v104, v104, v82
    s_waitcnt vmcnt(12)
    v_mfma_f32_16x16x32_bf16 v[24:27], a[176:179], a[104:107], v[24:27]
    buffer_load_dwordx4 a[96:99], v244, s[52:55], s77 offen sc1
    v_mul_f32 v105, v105, v82
    v_mfma_f32_16x16x32_bf16 v[40:43], a[180:183], a[104:107], v[40:43]
    ds_write_b128 v192, v[52:55] offset:2048
    s_waitcnt vmcnt(12)
    v_mfma_f32_16x16x32_bf16 v[24:27], a[192:195], a[120:123], v[24:27]
    v_mul_f32 v106, v106, v82
    v_mul_f32 v107, v107, v82
    v_mfma_f32_16x16x32_bf16 v[40:43], a[196:199], a[120:123], v[40:43]
    buffer_load_dwordx4 a[112:115], v244, s[52:55], s78 offen sc1
    v_lshlrev_b32 v108, 16, v88
    v_mfma_f32_16x16x32_bf16 v[56:59], a[232:235], a[40:43], v[56:59]
    s_waitcnt vmcnt(11)
    v_cmp_ne_u64 vcc, s[42:43], v[248:249]
    s_cbranch_vccnz L_pl_24
L_pd_25:
    v_mfma_f32_16x16x32_bf16 v[72:75], a[236:239], a[40:43], v[72:75]
    ds_write_b128 v192, v[68:71] offset:3072
    v_mfma_f32_16x16x32_bf16 v[56:59], a[136:139], a[56:59], v[56:59]
    s_add_u32 m0, s22, 100352
    s_nop 0
    buffer_load_dwordx4 v7, s[52:55], s19 offen sc1 lds
    v_mfma_f32_16x16x32_bf16 v[72:75], a[140:143], a[56:59], v[72:75]
    v_and_b32 v109, 0xffff0000, v88
    v_lshlrev_b32 v110, 16, v89
    v_mfma_f32_16x16x32_bf16 v[56:59], a[152:155], a[72:75], v[56:59]
    ds_write_b128 v193, v[24:27] offset:0
    v_mfma_f32_16x16x32_bf16 v[72:75], a[156:159], a[72:75], v[72:75]
    buffer_load_dwordx4 v7, s[52:55], s21 offen offset:1024 sc1 lds
    v_and_b32 v111, 0xffff0000, v89
    v_mfma_f32_16x16x32_bf16 v[56:59], a[168:171], a[88:91], v[56:59]
    v_mul_f32 v108, v108, v82
    v_mul_f32 v109, v109, v82
    v_mfma_f32_16x16x32_bf16 v[72:75], a[172:175], a[88:91], v[72:75]
    ds_write_b128 v193, v[40:43] offset:1024
    v_mfma_f32_16x16x32_bf16 v[56:59], a[184:187], a[104:107], v[56:59]
    v_mul_f32 v110, v110, v82
    v_mul_f32 v111, v111, v82
    v_mfma_f32_16x16x32_bf16 v[72:75], a[188:191], a[104:107], v[72:75]
    v_lshlrev_b32 v112, 16, v90
    v_and_b32 v113, 0xffff0000, v90
    v_mfma_f32_16x16x32_bf16 v[56:59], a[200:203], a[120:123], v[56:59]
    v_lshlrev_b32 v114, 16, v91
    v_and_b32 v115, 0xffff0000, v91
    v_mfma_f32_16x16x32_bf16 v[72:75], a[204:207], a[120:123], v[72:75]
    v_mul_f32 v112, v112, v82
    v_mul_f32 v113, v113, v82
    v_mfma_f32_16x16x32_bf16 v[28:31], a[224:227], a[44:47], v[28:31]
    v_mul_f32 v114, v114, v82
    v_mul_f32 v115, v115, v82
    v_mfma_f32_16x16x32_bf16 v[44:47], a[228:231], a[44:47], v[44:47]
    ds_write_b128 v193, v[56:59] offset:2048
    s_waitcnt vmcnt(12)
    v_mfma_f32_16x16x32_bf16 v[28:31], a[128:131], a[60:63], v[28:31]
    v_mfma_f32_16x16x32_bf16 v[44:47], a[132:135], a[60:63], v[44:47]
    s_waitcnt vmcnt(11)
    v_mfma_f32_16x16x32_bf16 v[28:31], a[144:147], a[76:79], v[28:31]
    ds_write_b128 v193, v[72:75] offset:3072
    v_mfma_f32_16x16x32_bf16 v[44:47], a[148:151], a[76:79], v[44:47]
    s_waitcnt vmcnt(10)
    v_mfma_f32_16x16x32_bf16 v[28:31], a[160:163], a[92:95], v[28:31]
    v_mfma_f32_16x16x32_bf16 v[44:47], a[164:167], a[92:95], v[44:47]
    s_waitcnt vmcnt(9)
    v_mfma_f32_16x16x32_bf16 v[28:31], a[176:179], a[108:111], v[28:31]
    v_mfma_f32_16x16x32_bf16 v[44:47], a[180:183], a[108:111], v[44:47]
    s_waitcnt vmcnt(8)
    v_mfma_f32_16x16x32_bf16 v[28:31], a[192:195], a[124:127], v[28:31]
    v_mfma_f32_16x16x32_bf16 v[44:47], a[196:199], a[124:127], v[44:47]
    v_mfma_f32_16x16x32_bf16 v[60:63], a[232:235], a[44:47], v[60:63]
    v_mfma_f32_16x16x32_bf16 v[76:79], a[236:239], a[44:47], v[76:79]
    v_mfma_f32_16x16x32_bf16 v[60:63], a[136:139], a[60:63], v[60:63]
    s_waitcnt lgkmcnt(0)
    s_barrier
    ds_read_b128 v[128:131], v197 offset:0
    v_mfma_f32_16x16x32_bf16 v[76:79], a[140:143], a[60:63], v[76:79]
    ds_read_b128 v[144:147], v197 offset:4096
    v_mfma_f32_16x16x32_bf16 v[60:63], a[152:155], a[76:79], v[60:63]
    ds_read_b128 v[132:135], v197 offset:1024
    v_mfma_f32_16x16x32_bf16 v[76:79], a[156:159], a[76:79], v[76:79]
    ds_read_b128 v[148:151], v197 offset:5120
    v_mfma_f32_16x16x32_bf16 v[60:63], a[168:171], a[92:95], v[60:63]
    ds_read_b128 v[136:139], v197 offset:2048
    v_mfma_f32_16x16x32_bf16 v[76:79], a[172:175], a[92:95], v[76:79]
    ds_read_b128 v[152:155], v197 offset:6144
    v_mfma_f32_16x16x32_bf16 v[60:63], a[184:187], a[108:111], v[60:63]
    ds_read_b128 v[140:143], v197 offset:3072
    v_mfma_f32_16x16x32_bf16 v[76:79], a[188:191], a[108:111], v[76:79]
    ds_read_b128 v[156:159], v197 offset:7168
    v_mfma_f32_16x16x32_bf16 v[60:63], a[200:203], a[124:127], v[60:63]
    ds_write_b128 v194, v[28:31] offset:0
    v_mfma_f32_16x16x32_bf16 v[76:79], a[204:207], a[124:127], v[76:79]
    s_waitcnt lgkmcnt(7)
    v_add_f32 v128, v128, v144
    v_add_f32 v129, v129, v145
    s_waitcnt vmcnt(7)
    v_mfma_f32_16x16x32_bf16 v[16:19], a[224:227], a[32:35], v[16:19]
    v_add_f32 v130, v130, v146
    v_add_f32 v131, v131, v147
    v_mfma_f32_16x16x32_bf16 v[32:35], a[228:231], a[32:35], v[32:35]
    s_waitcnt lgkmcnt(5)
    ds_write_b128 v194, v[44:47] offset:1024
    s_waitcnt vmcnt(6)
    v_mfma_f32_16x16x32_bf16 v[16:19], a[128:131], a[48:51], v[16:19]
    v_add_f32 v132, v132, v148
    v_add_f32 v133, v133, v149
    v_mfma_f32_16x16x32_bf16 v[32:35], a[132:135], a[48:51], v[32:35]
    v_add_f32 v134, v134, v150
    v_add_f32 v135, v135, v151
    s_waitcnt vmcnt(5)
    v_mfma_f32_16x16x32_bf16 v[16:19], a[144:147], a[64:67], v[16:19]
    s_waitcnt lgkmcnt(4)
    ds_write_b128 v194, v[60:63] offset:2048
    v_mfma_f32_16x16x32_bf16 v[32:35], a[148:151], a[64:67], v[32:35]
    v_add_f32 v136, v136, v152
    v_add_f32 v137, v137, v153
    s_waitcnt vmcnt(4)
    v_mfma_f32_16x16x32_bf16 v[16:19], a[160:163], a[80:83], v[16:19]
    v_add_f32 v138, v138, v154
    v_add_f32 v139, v139, v155
    v_mfma_f32_16x16x32_bf16 v[32:35], a[164:167], a[80:83], v[32:35]
    s_waitcnt lgkmcnt(3)
    ds_write_b128 v194, v[76:79] offset:3072
    s_waitcnt vmcnt(3)
    v_mfma_f32_16x16x32_bf16 v[16:19], a[176:179], a[96:99], v[16:19]
    v_add_f32 v140, v140, v156
    v_add_f32 v141, v141, v157
    v_mfma_f32_16x16x32_bf16 v[32:35], a[180:183], a[96:99], v[32:35]
    v_add_f32 v142, v142, v158
    v_add_f32 v143, v143, v159
    s_waitcnt vmcnt(2)
    v_mfma_f32_16x16x32_bf16 v[16:19], a[192:195], a[112:115], v[16:19]
    v_mfma_f32_16x16x32_bf16 v[32:35], a[196:199], a[112:115], v[32:35]
    v_mfma_f32_16x16x32_bf16 v[48:51], a[232:235], a[32:35], v[48:51]
    v_mfma_f32_16x16x32_bf16 v[64:67], a[236:239], a[32:35], v[64:67]
    v_add_f32 v16, v16, v128
    v_add_f32 v17, v17, v129
    v_mfma_f32_16x16x32_bf16 v[48:51], a[136:139], a[48:51], v[48:51]
    v_add_f32 v18, v18, v130
    v_add_f32 v19, v19, v131
    v_mfma_f32_16x16x32_bf16 v[64:67], a[140:143], a[48:51], v[64:67]
    v_add_f32 v32, v32, v132
    v_add_f32 v33, v33, v133
    v_mfma_f32_16x16x32_bf16 v[48:51], a[152:155], a[64:67], v[48:51]
    s_waitcnt vmcnt(0) lgkmcnt(0)
    s_barrier
    ds_read_b64_tr_b16 v[92:93], v196 offset:0
    v_mfma_f32_16x16x32_bf16 v[64:67], a[156:159], a[64:67], v[64:67]
    ds_read_b128 v[160:163], v197 offset:8192
    v_add_f32 v34, v34, v134
    v_mfma_f32_16x16x32_bf16 v[48:51], a[168:171], a[80:83], v[48:51]
    ds_read_b64_tr_b16 v[94:95], v196 offset:4096
    v_add_f32 v35, v35, v135
    v_mfma_f32_16x16x32_bf16 v[64:67], a[172:175], a[80:83], v[64:67]
    ds_read_b128 v[164:167], v197 offset:9216
    v_mfma_f32_16x16x32_bf16 v[48:51], a[184:187], a[96:99], v[48:51]
    ds_read_b64_tr_b16 v[96:97], v196 offset:8192
    v_mfma_f32_16x16x32_bf16 v[64:67], a[188:191], a[96:99], v[64:67]
    ds_read_b128 v[168:171], v197 offset:10240
    v_mfma_f32_16x16x32_bf16 v[48:51], a[200:203], a[112:115], v[48:51]
    ds_read_b64_tr_b16 v[98:99], v196 offset:12288
    v_mfma_f32_16x16x32_bf16 v[64:67], a[204:207], a[112:115], v[64:67]
    ds_read_b128 v[172:175], v197 offset:11264
    s_cmp_eq_u32 s27, 0
    s_cbranch_scc1 L_wb_26
L_wd_27:
    s_nop 3
    v_pk_add_f32 v[48:49], v[48:49], v[136:137]
    v_pk_add_f32 v[50:51], v[50:51], v[138:139]
    v_pk_add_f32 v[64:65], v[64:65], v[140:141]
    v_pk_add_f32 v[66:67], v[66:67], v[142:143]
    s_waitcnt lgkmcnt(6)
    v_lshlrev_b32 v224, 16, v92
    v_and_b32 v225, 0xffff0000, v92
    v_lshlrev_b32 v226, 16, v93
    v_and_b32 v227, 0xffff0000, v93
    v_pk_mul_f32 v[100:101], v[100:101], v[224:225]
    v_pk_mul_f32 v[102:103], v[102:103], v[226:227]
    v_pk_add_f32 v[16:17], v[16:17], v[160:161]
    v_pk_add_f32 v[18:19], v[18:19], v[162:163]
    v_pk_fma_f32 v[100:101], v[16:17], v[80:81], v[100:101] op_sel:[0,0,0] op_sel_hi:[1,0,1]
    v_pk_fma_f32 v[102:103], v[18:19], v[80:81], v[102:103] op_sel:[0,0,0] op_sel_hi:[1,0,1]
    v_cvt_pk_bf16_f32 v116, v100, v101
    v_cvt_pk_bf16_f32 v117, v102, v103
    s_waitcnt lgkmcnt(4)
    v_lshlrev_b32 v224, 16, v94
    v_and_b32 v225, 0xffff0000, v94
    v_lshlrev_b32 v226, 16, v95
    v_and_b32 v227, 0xffff0000, v95
    v_pk_mul_f32 v[104:105], v[104:105], v[224:225]
    v_pk_mul_f32 v[106:107], v[106:107], v[226:227]
    v_pk_add_f32 v[32:33], v[32:33], v[164:165]
    v_pk_add_f32 v[34:35], v[34:35], v[166:167]
    v_pk_fma_f32 v[104:105], v[32:33], v[80:81], v[104:105] op_sel:[0,0,0] op_sel_hi:[1,0,1]
    v_pk_fma_f32 v[106:107], v[34:35], v[80:81], v[106:107] op_sel:[0,0,0] op_sel_hi:[1,0,1]
    v_cvt_pk_bf16_f32 v118, v104, v105
    v_cvt_pk_bf16_f32 v119, v106, v107
    s_nop 1
    v_permlane16_swap_b32 v116, v118
    v_permlane16_swap_b32 v117, v119
    buffer_store_dwordx4 v[116:119], v198, s[68:71], s31 offen offset:0 sc1
    s_waitcnt lgkmcnt(2)
    v_lshlrev_b32 v224, 16, v96
    v_and_b32 v225, 0xffff0000, v96
    v_lshlrev_b32 v226, 16, v97
    v_and_b32 v227, 0xffff0000, v97
    v_pk_mul_f32 v[108:109], v[108:109], v[224:225]
    v_pk_mul_f32 v[110:111], v[110:111], v[226:227]
    v_pk_add_f32 v[48:49], v[48:49], v[168:169]
    v_pk_add_f32 v[50:51], v[50:51], v[170:171]
    v_pk_fma_f32 v[108:109], v[48:49], v[80:81], v[108:109] op_sel:[0,0,0] op_sel_hi:[1,0,1]
    v_pk_fma_f32 v[110:111], v[50:51], v[80:81], v[110:111] op_sel:[0,0,0] op_sel_hi:[1,0,1]
    v_cvt_pk_bf16_f32 v120, v108, v109
    v_cvt_pk_bf16_f32 v121, v110, v111
    s_waitcnt lgkmcnt(0)
    v_lshlrev_b32 v224, 16, v98
    v_and_b32 v225, 0xffff0000, v98
    v_lshlrev_b32 v226, 16, v99
    v_and_b32 v227, 0xffff0000, v99
    v_pk_mul_f32 v[112:113], v[112:113], v[224:225]
    v_pk_mul_f32 v[114:115], v[114:115], v[226:227]
    v_pk_add_f32 v[64:65], v[64:65], v[172:173]
    v_pk_add_f32 v[66:67], v[66:67], v[174:175]
    v_pk_fma_f32 v[112:113], v[64:65], v[80:81], v[112:113] op_sel:[0,0,0] op_sel_hi:[1,0,1]
    v_pk_fma_f32 v[114:115], v[66:67], v[80:81], v[114:115] op_sel:[0,0,0] op_sel_hi:[1,0,1]
    v_cvt_pk_bf16_f32 v122, v112, v113
    v_cvt_pk_bf16_f32 v123, v114, v115
    s_nop 1
    v_permlane16_swap_b32 v120, v122
    v_permlane16_swap_b32 v121, v123
    buffer_store_dwordx4 v[120:123], v198, s[68:71], s31 offen offset:64 sc1
L_end:
    s_endpgm
L_spare:
    s_sub_u32 s24, s5, 28
    s_lshl_b32 s24, s24, 2
    s_add_u32 s6, s24, s3
    v_lshrrev_b32 v5, 3, v1
    v_and_b32 v6, 7, v1
    s_lshl_b32 s24, s6, 17
    s_lshl_b32 s25, s4, 7
    s_add_u32 s24, s24, s25
    v_lshl_add_u32 v254, v1, 10, s24
    v_lshlrev_b32 v7, 13, v5
    v_lshl_add_u32 v7, v6, 4, v7
    v_add_u32 v7, s24, v7
    v_subrev_u32 v8, 3072, v7
    v_mov_b32 v9, 0x80000000
    v_cmp_gt_u32 vcc, 3072, v7
    s_lshl_b32 s25, s4, 9
    s_nop 0
    v_cndmask_b32 v8, v8, v9, vcc
    v_lshlrev_b32 v9, 6, v6
    v_add_u32 v9, s25, v9
    s_mov_b32 s12, 4096
    s_mov_b32 s13, 65536
    s_mov_b32 s14, 69632
    s_mov_b32 s15, 62464
    s_mov_b32 s74, 2097152
    s_mov_b32 s75, 0x00020000
    s_mov_b32 s78, 2097152
    s_mov_b32 s79, 0x00020000
    s_mov_b32 s82, 4096
    s_mov_b32 s83, 0x00020000
    s_mov_b32 s54, 18874368
    s_mov_b32 s55, 0x00020000
    s_mov_b32 s58, 256
    s_mov_b32 s59, 0x00020000
    s_mov_b32 s62, 2097152
    s_mov_b32 s63, 0x00020000
    v_and_b32 v3, 15, v1
    v_lshrrev_b32 v4, 4, v1
    v_mov_b32 v10, 0
    s_lshl_b32 s8, s4, 2
    s_and_b32 s9, s5, 3
    s_add_u32 s8, s8, s9
    s_lshr_b32 s9, s5, 2
    s_lshl_b32 s10, s4, 5
    s_add_u32 s10, s10, s5
    s_lshr_b32 s32, s3, 1
    s_and_b32 s33, s3, 1
    s_lshl_b32 s34, s10, 1
    s_add_u32 s34, s34, s32
    s_lshl_b32 s35, s34, 12
    s_lshl_b32 s36, s33, 11
    s_add_u32 s37, s35, s36
    s_load_dwordx2 s[80:81], s[0:1], 24
    s_load_dwordx2 s[60:61], s[0:1], 32
    s_load_dwordx2 s[56:57], s[0:1], 88
    s_load_dwordx2 s[84:85], s[0:1], 72
    s_load_dwordx2 s[64:65], s[0:1], 64
    s_load_dwordx2 s[68:69], s[0:1], 80
    s_load_dwordx2 s[40:41], s[0:1], 40
    s_memrealtime s[42:43]
    s_waitcnt lgkmcnt(0)
    buffer_load_dwordx4 v[144:147], v11, s[60:63], s37 offen
    buffer_load_dwordx4 v[150:153], v11, s[60:63], s37 offen offset:1024
    buffer_load_dwordx4 v[232:235], v9, s[80:83], 0 offen offset:0
    buffer_load_dwordx4 v[236:239], v9, s[80:83], 0 offen offset:16
    buffer_load_dwordx4 v[240:243], v9, s[80:83], 0 offen offset:32
    buffer_load_dwordx4 v[244:247], v9, s[80:83], 0 offen offset:48
    buffer_load_dwordx4 v[16:19], v8, s[72:75], 0 offen offset:0
    buffer_load_dwordx4 v[20:23], v8, s[72:75], 0 offen offset:1024
    buffer_load_dwordx4 v[24:27], v8, s[72:75], 0 offen offset:2048
    buffer_load_dwordx4 v[28:31], v7, s[72:75], 0 offen offset:0
    buffer_load_dwordx4 v[104:107], v7, s[76:79], 0 offen offset:0
    buffer_load_dwordx4 v[32:35], v7, s[72:75], 0 offen offset:1024
    s_lshl_b32 s38, s10, 2
    s_load_dword s39, s[40:41], s38
    s_load_dwordx2 s[94:95], s[60:61], s35
    s_add_u32 s38, s35, 2048
    s_load_dwordx2 s[96:97], s[60:61], s38
    s_mov_b32 s46, 2097152
    s_mov_b32 s47, 0x00020000
    s_mov_b32 s86, 1024
    s_mov_b32 s87, 0x00020000
    s_mov_b32 s66, 1835008
    s_mov_b32 s67, 0x00020000
    s_mov_b32 s70, 2097152
    s_mov_b32 s71, 0x00020000
    v_sub_u32 v8, 7, v5
    v_xor_b32 v8, v8, v6
    v_lshlrev_b32 v8, 4, v8
    v_lshl_add_u32 v8, v6, 10, v8
    s_lshl_b32 s24, s3, 14
    v_add_u32 v8, s24, v8
    v_add_u32 v15, s24, v11
    v_lshlrev_b32 v5, 12, v5
    v_lshl_add_u32 v250, v6, 4, v5
    s_lshl_b32 s24, s4, 18
    s_lshl_b32 s25, s6, 8
    s_sub_u32 s24, s24, s25
    s_add_u32 s11, s24, 3840
    s_waitcnt lgkmcnt(0)
    s_waitcnt vmcnt(10)
    v_mov_b32_dpp v148, v144 wave_shl:1 row_mask:0xf bank_mask:0xf
    v_mov_b32_dpp v149, v145 wave_shl:1 row_mask:0xf bank_mask:0xf
    v_mov_b32_dpp v154, v150 wave_shl:1 row_mask:0xf bank_mask:0xf
    v_mov_b32_dpp v155, v151 wave_shl:1 row_mask:0xf bank_mask:0xf
    v_readlane_b32 s24, v150, 0
    v_readlane_b32 s25, v151, 0
    v_writelane_b32 v154, s96, 63
    v_writelane_b32 v155, s97, 63
    v_writelane_b32 v148, s24, 63
    v_writelane_b32 v149, s25, 63
    v_alignbyte_b32 v156, v145, v144, 2
    v_alignbyte_b32 v157, v146, v145, 2
    v_alignbyte_b32 v158, v147, v146, 2
    v_alignbyte_b32 v159, v148, v147, 2
    v_mov_b32 v160, v145
    v_mov_b32 v161, v146
    v_mov_b32 v162, v147
    v_mov_b32 v163, v148
    v_mov_b32 v164, v157
    buffer_load_dwordx4 v[108:111], v7, s[76:79], 0 offen offset:1024
    buffer_load_dwordx4 v[36:39], v7, s[72:75], 0 offen offset:2048
    v_mov_b32 v165, v158
    v_mov_b32 v166, v159
    v_alignbyte_b32 v167, v149, v148, 2
    v_alignbyte_b32 v168, v151, v150, 2
    v_alignbyte_b32 v169, v152, v151, 2
    v_alignbyte_b32 v170, v153, v152, 2
    v_alignbyte_b32 v171, v154, v153, 2
    v_mov_b32 v172, v151
    v_mov_b32 v173, v152
    v_mov_b32 v174, v153
    v_mov_b32 v175, v154
    v_mov_b32 v176, v169
    v_mov_b32 v177, v170
    v_mov_b32 v178, v171
    v_alignbyte_b32 v179, v155, v154, 2
    s_lshl_b32 s24, s94, 16
    s_lshr_b32 s25, s94, 16
    s_lshl_b32 s31, s95, 16
    s_or_b32 s25, s25, s31
    v_mov_b32 v180, 0
    v_mov_b32 v181, 0
    v_mov_b32 v182, 0
    v_mov_b32 v183, 0
    v_writelane_b32 v183, s24, 3
    v_writelane_b32 v183, s94, 5
    v_writelane_b32 v182, s24, 7
    v_writelane_b32 v183, s25, 7
    s_mul_i32 s18, s32, 16640
    s_add_u32 s18, s18, 130560
    s_mul_i32 s20, s32, 4608
    s_add_u32 s20, s20, 121344
    s_add_u32 s24, s18, s36
    buffer_load_dwordx4 v[112:115], v7, s[76:79], 0 offen offset:2048
    buffer_load_dwordx4 v[40:43], v7, s[72:75], 0 offen offset:3072
    v_add_u32 v185, s24, v11
    v_bfe_u32 v5, v1, 1, 2
    v_mul_u32_u24 v5, 4160, v5
    v_and_b32 v6, 1, v1
    v_cmp_gt_u32 vcc, 8, v1
    v_lshl_add_u32 v5, v6, 4, v5
    v_add_u32 v5, s18, v5
    s_add_u32 s24, s20, 4096
    v_subrev_u32 v6, 128, v11
    v_and_b32 v6, 511, v6
    v_add_u32 v6, s24, v6
    v_cndmask_b32 v184, v6, v5, vcc
    ds_write_b128 v185, v[144:147] offset:32
    ds_write_b128 v185, v[156:159] offset:4192
    ds_write_b128 v185, v[160:163] offset:8352
    buffer_load_dwordx4 v[116:119], v7, s[76:79], 0 offen offset:3072
    buffer_load_dwordx4 v[44:47], v7, s[72:75], s12 offen offset:0
    ds_write_b128 v185, v[164:167] offset:12512
    ds_write_b128 v185, v[150:153] offset:1056
    buffer_load_dwordx4 v[120:123], v7, s[76:79], s12 offen offset:0
    buffer_load_dwordx4 v[48:51], v7, s[72:75], s12 offen offset:1024
    ds_write_b128 v185, v[168:171] offset:5216
    ds_write_b128 v185, v[172:175] offset:9376
    ds_write_b128 v185, v[176:179] offset:13536
    buffer_load_dwordx4 v[124:127], v7, s[76:79], s12 offen offset:1024
    buffer_load_dwordx4 v[52:55], v7, s[72:75], s12 offen offset:2048
    ds_write_b128 v184, v[180:183]
    buffer_load_dwordx4 v[128:131], v7, s[76:79], s12 offen offset:2048
    buffer_load_dwordx4 v[56:59], v7, s[72:75], s12 offen offset:3072
    buffer_load_dwordx4 v[132:135], v7, s[76:79], s12 offen offset:3072
    v_and_b32 v14, 7, v1
    v_lshlrev_b32 v14, 3, v14
    buffer_load_dwordx2 v[248:249], v14, s[56:59], 0 offen sc1
    s_waitcnt vmcnt(20)
    v_lshlrev_b32 v200, 16, v232
    v_and_b32 v208, 0xffff0000, v232
    v_lshlrev_b32 v216, 16, v233
    v_and_b32 v224, 0xffff0000, v233
    v_lshlrev_b32 v201, 16, v234
    v_and_b32 v209, 0xffff0000, v234
    v_lshlrev_b32 v217, 16, v235
    v_and_b32 v225, 0xffff0000, v235
    v_lshlrev_b32 v202, 16, v236
    v_and_b32 v210, 0xffff0000, v236
    v_lshlrev_b32 v218, 16, v237
    v_and_b32 v226, 0xffff0000, v237
    v_lshlrev_b32 v203, 16, v238
    v_and_b32 v211, 0xffff0000, v238
    v_lshlrev_b32 v219, 16, v239
    v_and_b32 v227, 0xffff0000, v239
    v_lshlrev_b32 v204, 16, v240
    v_and_b32 v212, 0xffff0000, v240
    v_lshlrev_b32 v220, 16, v241
    v_and_b32 v228, 0xffff0000, v241
    v_lshlrev_b32 v205, 16, v242
    v_and_b32 v213, 0xffff0000, v242
    v_lshlrev_b32 v221, 16, v243
    v_and_b32 v229, 0xffff0000, v243
    v_lshlrev_b32 v206, 16, v244
    v_and_b32 v214, 0xffff0000, v244
    v_lshlrev_b32 v222, 16, v245
    v_and_b32 v230, 0xffff0000, v245
    v_lshlrev_b32 v207, 16, v246
    v_and_b32 v215, 0xffff0000, v246
    v_lshlrev_b32 v223, 16, v247
    v_and_b32 v231, 0xffff0000, v247
    s_waitcnt vmcnt(19)
    v_lshlrev_b32 v168, 16, v16
    v_and_b32 v169, 0xffff0000, v16
    v_lshlrev_b32 v170, 16, v17
    v_and_b32 v171, 0xffff0000, v17
    v_lshlrev_b32 v172, 16, v18
    v_and_b32 v173, 0xffff0000, v18
    v_lshlrev_b32 v174, 16, v19
    v_and_b32 v175, 0xffff0000, v19
    s_waitcnt vmcnt(18)
    v_lshlrev_b32 v176, 16, v20
    v_and_b32 v177, 0xffff0000, v20
    v_lshlrev_b32 v178, 16, v21
    v_and_b32 v179, 0xffff0000, v21
    v_lshlrev_b32 v180, 16, v22
    v_and_b32 v181, 0xffff0000, v22
    v_lshlrev_b32 v182, 16, v23
    v_and_b32 v183, 0xffff0000, v23
    s_waitcnt vmcnt(17)
    v_lshlrev_b32 v184, 16, v24
    v_and_b32 v185, 0xffff0000, v24
    v_lshlrev_b32 v186, 16, v25
    v_and_b32 v187, 0xffff0000, v25
    v_lshlrev_b32 v188, 16, v26
    v_and_b32 v189, 0xffff0000, v26
    v_lshlrev_b32 v190, 16, v27
    v_and_b32 v191, 0xffff0000, v27
    s_waitcnt vmcnt(15)
    v_lshlrev_b32 v192, 16, v28
    v_and_b32 v193, 0xffff0000, v28
    v_lshlrev_b32 v194, 16, v29
    v_and_b32 v195, 0xffff0000, v29
    v_lshlrev_b32 v196, 16, v30
    v_and_b32 v197, 0xffff0000, v30
    v_lshlrev_b32 v198, 16, v31
    v_and_b32 v199, 0xffff0000, v31
    v_lshlrev_b32 v16, 16, v104
    v_and_b32 v17, 0xffff0000, v104
    v_lshlrev_b32 v18, 16, v105
    v_and_b32 v19, 0xffff0000, v105
    v_lshlrev_b32 v20, 16, v106
    v_and_b32 v21, 0xffff0000, v106
    v_lshlrev_b32 v22, 16, v107
    v_and_b32 v23, 0xffff0000, v107
    buffer_load_dwordx4 v[60:63], v7, s[72:75], s15 offen offset:0
    buffer_load_dwordx4 v[64:67], v7, s[72:75], s15 offen offset:1024
    buffer_load_dwordx4 v[68:71], v7, s[72:75], s15 offen offset:2048
    buffer_load_dwordx4 v[72:75], v7, s[72:75], s13 offen offset:0
    buffer_load_dwordx4 v[104:107], v7, s[76:79], s13 offen offset:0
    v_pk_mul_f32 v[232:233], v[168:169], v[224:225]
    v_pk_mul_f32 v[234:235], v[170:171], v[226:227]
    v_pk_mul_f32 v[236:237], v[172:173], v[228:229]
    v_pk_mul_f32 v[238:239], v[174:175], v[230:231]
    v_pk_fma_f32 v[232:233], v[176:177], v[216:217], v[232:233]
    v_pk_fma_f32 v[234:235], v[178:179], v[218:219], v[234:235]
    v_pk_fma_f32 v[236:237], v[180:181], v[220:221], v[236:237]
    v_pk_fma_f32 v[238:239], v[182:183], v[222:223], v[238:239]
    v_pk_fma_f32 v[232:233], v[184:185], v[208:209], v[232:233]
    v_pk_fma_f32 v[234:235], v[186:187], v[210:211], v[234:235]
    v_pk_fma_f32 v[236:237], v[188:189], v[212:213], v[236:237]
    v_pk_fma_f32 v[238:239], v[190:191], v[214:215], v[238:239]
    v_pk_fma_f32 v[232:233], v[192:193], v[200:201], v[232:233]
    v_pk_fma_f32 v[234:235], v[194:195], v[202:203], v[234:235]
    v_pk_fma_f32 v[236:237], v[196:197], v[204:205], v[236:237]
    v_pk_fma_f32 v[238:239], v[198:199], v[206:207], v[238:239]
    v_pk_mul_f32 v[232:233], v[232:233], v[16:17]
    v_pk_mul_f32 v[234:235], v[234:235], v[18:19]
    v_pk_mul_f32 v[236:237], v[236:237], v[20:21]
    v_pk_mul_f32 v[238:239], v[238:239], v[22:23]
    s_waitcnt vmcnt(18)
    v_lshlrev_b32 v168, 16, v32
    v_and_b32 v169, 0xffff0000, v32
    v_lshlrev_b32 v170, 16, v33
    v_and_b32 v171, 0xffff0000, v33
    v_lshlrev_b32 v172, 16, v34
    v_and_b32 v173, 0xffff0000, v34
    v_lshlrev_b32 v174, 16, v35
    v_and_b32 v175, 0xffff0000, v35
    v_lshlrev_b32 v16, 16, v108
    v_and_b32 v17, 0xffff0000, v108
    v_lshlrev_b32 v18, 16, v109
    v_and_b32 v19, 0xffff0000, v109
    v_lshlrev_b32 v20, 16, v110
    v_and_b32 v21, 0xffff0000, v110
    v_lshlrev_b32 v22, 16, v111
    v_and_b32 v23, 0xffff0000, v111
    buffer_load_dwordx4 v[76:79], v7, s[72:75], s13 offen offset:1024
    buffer_load_dwordx4 v[108:111], v7, s[76:79], s13 offen offset:1024
    v_pk_mul_f32 v[240:241], v[176:177], v[224:225]
    v_pk_mul_f32 v[242:243], v[178:179], v[226:227]
    v_pk_mul_f32 v[244:245], v[180:181], v[228:229]
    v_pk_mul_f32 v[246:247], v[182:183], v[230:231]
    v_pk_fma_f32 v[240:241], v[184:185], v[216:217], v[240:241]
    v_pk_fma_f32 v[242:243], v[186:187], v[218:219], v[242:243]
    v_pk_fma_f32 v[244:245], v[188:189], v[220:221], v[244:245]
    v_pk_fma_f32 v[246:247], v[190:191], v[222:223], v[246:247]
    v_pk_fma_f32 v[240:241], v[192:193], v[208:209], v[240:241]
    v_pk_fma_f32 v[242:243], v[194:195], v[210:211], v[242:243]
    v_pk_fma_f32 v[244:245], v[196:197], v[212:213], v[244:245]
    v_pk_fma_f32 v[246:247], v[198:199], v[214:215], v[246:247]
    v_pk_fma_f32 v[240:241], v[168:169], v[200:201], v[240:241]
    v_pk_fma_f32 v[242:243], v[170:171], v[202:203], v[242:243]
    v_pk_fma_f32 v[244:245], v[172:173], v[204:205], v[244:245]
    v_pk_fma_f32 v[246:247], v[174:175], v[206:207], v[246:247]
    v_pk_mul_f32 v[240:241], v[240:241], v[16:17]
    v_pk_mul_f32 v[242:243], v[242:243], v[18:19]
    v_pk_mul_f32 v[244:245], v[244:245], v[20:21]
    v_pk_mul_f32 v[246:247], v[246:247], v[22:23]
    v_cvt_pk_bf16_f32 v139, v240, v232
    v_cvt_pk_bf16_f32 v143, v241, v233
    v_cvt_pk_bf16_f32 v147, v242, v234
    v_cvt_pk_bf16_f32 v151, v243, v235
    v_cvt_pk_bf16_f32 v155, v244, v236
    v_cvt_pk_bf16_f32 v159, v245, v237
    v_cvt_pk_bf16_f32 v163, v246, v238
    v_cvt_pk_bf16_f32 v167, v247, v239
    s_waitcnt vmcnt(18)
    v_lshlrev_b32 v176, 16, v36
    v_and_b32 v177, 0xffff0000, v36
    v_lshlrev_b32 v178, 16, v37
    v_and_b32 v179, 0xffff0000, v37
    v_lshlrev_b32 v180, 16, v38
    v_and_b32 v181, 0xffff0000, v38
    v_lshlrev_b32 v182, 16, v39
    v_and_b32 v183, 0xffff0000, v39
    v_lshlrev_b32 v16, 16, v112
    v_and_b32 v17, 0xffff0000, v112
    v_lshlrev_b32 v18, 16, v113
    v_and_b32 v19, 0xffff0000, v113
    v_lshlrev_b32 v20, 16, v114
    v_and_b32 v21, 0xffff0000, v114
    v_lshlrev_b32 v22, 16, v115
    v_and_b32 v23, 0xffff0000, v115
    buffer_load_dwordx4 v[80:83], v7, s[72:75], s13 offen offset:2048
    buffer_load_dwordx4 v[112:115], v7, s[76:79], s13 offen offset:2048
    v_pk_mul_f32 v[232:233], v[184:185], v[224:225]
    v_pk_mul_f32 v[234:235], v[186:187], v[226:227]
    v_pk_mul_f32 v[236:237], v[188:189], v[228:229]
    v_pk_mul_f32 v[238:239], v[190:191], v[230:231]
    v_pk_fma_f32 v[232:233], v[192:193], v[216:217], v[232:233]
    v_pk_fma_f32 v[234:235], v[194:195], v[218:219], v[234:235]
    v_pk_fma_f32 v[236:237], v[196:197], v[220:221], v[236:237]
    v_pk_fma_f32 v[238:239], v[198:199], v[222:223], v[238:239]
    v_pk_fma_f32 v[232:233], v[168:169], v[208:209], v[232:233]
    v_pk_fma_f32 v[234:235], v[170:171], v[210:211], v[234:235]
    v_pk_fma_f32 v[236:237], v[172:173], v[212:213], v[236:237]
    v_pk_fma_f32 v[238:239], v[174:175], v[214:215], v[238:239]
    v_pk_fma_f32 v[232:233], v[176:177], v[200:201], v[232:233]
    v_pk_fma_f32 v[234:235], v[178:179], v[202:203], v[234:235]
    v_pk_fma_f32 v[236:237], v[180:181], v[204:205], v[236:237]
    v_pk_fma_f32 v[238:239], v[182:183], v[206:207], v[238:239]
    v_pk_mul_f32 v[232:233], v[232:233], v[16:17]
    v_pk_mul_f32 v[234:235], v[234:235], v[18:19]
    v_pk_mul_f32 v[236:237], v[236:237], v[20:21]
    v_pk_mul_f32 v[238:239], v[238:239], v[22:23]
    s_waitcnt vmcnt(18)
    v_lshlrev_b32 v184, 16, v40
    v_and_b32 v185, 0xffff0000, v40
    v_lshlrev_b32 v186, 16, v41
    v_and_b32 v187, 0xffff0000, v41
    v_lshlrev_b32 v188, 16, v42
    v_and_b32 v189, 0xffff0000, v42
    v_lshlrev_b32 v190, 16, v43
    v_and_b32 v191, 0xffff0000, v43
    v_lshlrev_b32 v16, 16, v116
    v_and_b32 v17, 0xffff0000, v116
    v_lshlrev_b32 v18, 16, v117
    v_and_b32 v19, 0xffff0000, v117
    v_lshlrev_b32 v20, 16, v118
    v_and_b32 v21, 0xffff0000, v118
    v_lshlrev_b32 v22, 16, v119
    v_and_b32 v23, 0xffff0000, v119
    buffer_load_dwordx4 v[84:87], v7, s[72:75], s13 offen offset:3072
    buffer_load_dwordx4 v[116:119], v7, s[76:79], s13 offen offset:3072
    v_pk_mul_f32 v[240:241], v[192:193], v[224:225]
    v_pk_mul_f32 v[242:243], v[194:195], v[226:227]
    v_pk_mul_f32 v[244:245], v[196:197], v[228:229]
    v_pk_mul_f32 v[246:247], v[198:199], v[230:231]
    v_pk_fma_f32 v[240:241], v[168:169], v[216:217], v[240:241]
    v_pk_fma_f32 v[242:243], v[170:171], v[218:219], v[242:243]
    v_pk_fma_f32 v[244:245], v[172:173], v[220:221], v[244:245]
    v_pk_fma_f32 v[246:247], v[174:175], v[222:223], v[246:247]
    v_pk_fma_f32 v[240:241], v[176:177], v[208:209], v[240:241]
    v_pk_fma_f32 v[242:243], v[178:179], v[210:211], v[242:243]
    v_pk_fma_f32 v[244:245], v[180:181], v[212:213], v[244:245]
    v_pk_fma_f32 v[246:247], v[182:183], v[214:215], v[246:247]
    v_pk_fma_f32 v[240:241], v[184:185], v[200:201], v[240:241]
    v_pk_fma_f32 v[242:243], v[186:187], v[202:203], v[242:243]
    v_pk_fma_f32 v[244:245], v[188:189], v[204:205], v[244:245]
    v_pk_fma_f32 v[246:247], v[190:191], v[206:207], v[246:247]
    v_pk_mul_f32 v[240:241], v[240:241], v[16:17]
    v_pk_mul_f32 v[242:243], v[242:243], v[18:19]
    v_pk_mul_f32 v[244:245], v[244:245], v[20:21]
    v_pk_mul_f32 v[246:247], v[246:247], v[22:23]
    v_cvt_pk_bf16_f32 v138, v240, v232
    v_cvt_pk_bf16_f32 v142, v241, v233
    v_cvt_pk_bf16_f32 v146, v242, v234
    v_cvt_pk_bf16_f32 v150, v243, v235
    v_cvt_pk_bf16_f32 v154, v244, v236
    v_cvt_pk_bf16_f32 v158, v245, v237
    v_cvt_pk_bf16_f32 v162, v246, v238
    v_cvt_pk_bf16_f32 v166, v247, v239
    s_waitcnt vmcnt(18)
    v_lshlrev_b32 v192, 16, v44
    v_and_b32 v193, 0xffff0000, v44
    v_lshlrev_b32 v194, 16, v45
    v_and_b32 v195, 0xffff0000, v45
    v_lshlrev_b32 v196, 16, v46
    v_and_b32 v197, 0xffff0000, v46
    v_lshlrev_b32 v198, 16, v47
    v_and_b32 v199, 0xffff0000, v47
    v_lshlrev_b32 v16, 16, v120
    v_and_b32 v17, 0xffff0000, v120
    v_lshlrev_b32 v18, 16, v121
    v_and_b32 v19, 0xffff0000, v121
    v_lshlrev_b32 v20, 16, v122
    v_and_b32 v21, 0xffff0000, v122
    v_lshlrev_b32 v22, 16, v123
    v_and_b32 v23, 0xffff0000, v123
    buffer_load_dwordx4 v[88:91], v7, s[72:75], s14 offen offset:0
    buffer_load_dwordx4 v[120:123], v7, s[76:79], s14 offen offset:0
    v_pk_mul_f32 v[232:233], v[168:169], v[224:225]
    v_pk_mul_f32 v[234:235], v[170:171], v[226:227]
    v_pk_mul_f32 v[236:237], v[172:173], v[228:229]
    v_pk_mul_f32 v[238:239], v[174:175], v[230:231]
    v_pk_fma_f32 v[232:233], v[176:177], v[216:217], v[232:233]
    v_pk_fma_f32 v[234:235], v[178:179], v[218:219], v[234:235]
    v_pk_fma_f32 v[236:237], v[180:181], v[220:221], v[236:237]
    v_pk_fma_f32 v[238:239], v[182:183], v[222:223], v[238:239]
    v_pk_fma_f32 v[232:233], v[184:185], v[208:209], v[232:233]
    v_pk_fma_f32 v[234:235], v[186:187], v[210:211], v[234:235]
    v_pk_fma_f32 v[236:237], v[188:189], v[212:213], v[236:237]
    v_pk_fma_f32 v[238:239], v[190:191], v[214:215], v[238:239]
    v_pk_fma_f32 v[232:233], v[192:193], v[200:201], v[232:233]
    v_pk_fma_f32 v[234:235], v[194:195], v[202:203], v[234:235]
    v_pk_fma_f32 v[236:237], v[196:197], v[204:205], v[236:237]
    v_pk_fma_f32 v[238:239], v[198:199], v[206:207], v[238:239]
    v_pk_mul_f32 v[232:233], v[232:233], v[16:17]
    v_pk_mul_f32 v[234:235], v[234:235], v[18:19]
    v_pk_mul_f32 v[236:237], v[236:237], v[20:21]
    v_pk_mul_f32 v[238:239], v[238:239], v[22:23]
    s_waitcnt vmcnt(18)
    v_lshlrev_b32 v168, 16, v48
    v_and_b32 v169, 0xffff0000, v48
    v_lshlrev_b32 v170, 16, v49
    v_and_b32 v171, 0xffff0000, v49
    v_lshlrev_b32 v172, 16, v50
    v_and_b32 v173, 0xffff0000, v50
    v_lshlrev_b32 v174, 16, v51
    v_and_b32 v175, 0xffff0000, v51
    v_lshlrev_b32 v16, 16, v124
    v_and_b32 v17, 0xffff0000, v124
    v_lshlrev_b32 v18, 16, v125
    v_and_b32 v19, 0xffff0000, v125
    v_lshlrev_b32 v20, 16, v126
    v_and_b32 v21, 0xffff0000, v126
    v_lshlrev_b32 v22, 16, v127
    v_and_b32 v23, 0xffff0000, v127
    buffer_load_dwordx4 v[92:95], v7, s[72:75], s14 offen offset:1024
    buffer_load_dwordx4 v[124:127], v7, s[76:79], s14 offen offset:1024
    v_pk_mul_f32 v[240:241], v[176:177], v[224:225]
    v_pk_mul_f32 v[242:243], v[178:179], v[226:227]
    v_pk_mul_f32 v[244:245], v[180:181], v[228:229]
    v_pk_mul_f32 v[246:247], v[182:183], v[230:231]
    v_pk_fma_f32 v[240:241], v[184:185], v[216:217], v[240:241]
    v_pk_fma_f32 v[242:243], v[186:187], v[218:219], v[242:243]
    v_pk_fma_f32 v[244:245], v[188:189], v[220:221], v[244:245]
    v_pk_fma_f32 v[246:247], v[190:191], v[222:223], v[246:247]
    v_pk_fma_f32 v[240:241], v[192:193], v[208:209], v[240:241]
    v_pk_fma_f32 v[242:243], v[194:195], v[210:211], v[242:243]
    v_pk_fma_f32 v[244:245], v[196:197], v[212:213], v[244:245]
    v_pk_fma_f32 v[246:247], v[198:199], v[214:215], v[246:247]
    v_pk_fma_f32 v[240:241], v[168:169], v[200:201], v[240:241]
    v_pk_fma_f32 v[242:243], v[170:171], v[202:203], v[242:243]
    v_pk_fma_f32 v[244:245], v[172:173], v[204:205], v[244:245]
    v_pk_fma_f32 v[246:247], v[174:175], v[206:207], v[246:247]
    v_pk_mul_f32 v[240:241], v[240:241], v[16:17]
    v_pk_mul_f32 v[242:243], v[242:243], v[18:19]
    v_pk_mul_f32 v[244:245], v[244:245], v[20:21]
    v_pk_mul_f32 v[246:247], v[246:247], v[22:23]
    v_cvt_pk_bf16_f32 v137, v240, v232
    v_cvt_pk_bf16_f32 v141, v241, v233
    v_cvt_pk_bf16_f32 v145, v242, v234
    v_cvt_pk_bf16_f32 v149, v243, v235
    v_cvt_pk_bf16_f32 v153, v244, v236
    v_cvt_pk_bf16_f32 v157, v245, v237
    v_cvt_pk_bf16_f32 v161, v246, v238
    v_cvt_pk_bf16_f32 v165, v247, v239
    s_waitcnt vmcnt(18)
    v_lshlrev_b32 v176, 16, v52
    v_and_b32 v177, 0xffff0000, v52
    v_lshlrev_b32 v178, 16, v53
    v_and_b32 v179, 0xffff0000, v53
    v_lshlrev_b32 v180, 16, v54
    v_and_b32 v181, 0xffff0000, v54
    v_lshlrev_b32 v182, 16, v55
    v_and_b32 v183, 0xffff0000, v55
    v_lshlrev_b32 v16, 16, v128
    v_and_b32 v17, 0xffff0000, v128
    v_lshlrev_b32 v18, 16, v129
    v_and_b32 v19, 0xffff0000, v129
    v_lshlrev_b32 v20, 16, v130
    v_and_b32 v21, 0xffff0000, v130
    v_lshlrev_b32 v22, 16, v131
    v_and_b32 v23, 0xffff0000, v131
    buffer_load_dwordx4 v[96:99], v7, s[72:75], s14 offen offset:2048
    buffer_load_dwordx4 v[128:131], v7, s[76:79], s14 offen offset:2048
    v_pk_mul_f32 v[232:233], v[184:185], v[224:225]
    v_pk_mul_f32 v[234:235], v[186:187], v[226:227]
    v_pk_mul_f32 v[236:237], v[188:189], v[228:229]
    v_pk_mul_f32 v[238:239], v[190:191], v[230:231]
    v_pk_fma_f32 v[232:233], v[192:193], v[216:217], v[232:233]
    v_pk_fma_f32 v[234:235], v[194:195], v[218:219], v[234:235]
    v_pk_fma_f32 v[236:237], v[196:197], v[220:221], v[236:237]
    v_pk_fma_f32 v[238:239], v[198:199], v[222:223], v[238:239]
    v_pk_fma_f32 v[232:233], v[168:169], v[208:209], v[232:233]
    v_pk_fma_f32 v[234:235], v[170:171], v[210:211], v[234:235]
    v_pk_fma_f32 v[236:237], v[172:173], v[212:213], v[236:237]
    v_pk_fma_f32 v[238:239], v[174:175], v[214:215], v[238:239]
    v_pk_fma_f32 v[232:233], v[176:177], v[200:201], v[232:233]
    v_pk_fma_f32 v[234:235], v[178:179], v[202:203], v[234:235]
    v_pk_fma_f32 v[236:237], v[180:181], v[204:205], v[236:237]
    v_pk_fma_f32 v[238:239], v[182:183], v[206:207], v[238:239]
    v_pk_mul_f32 v[232:233], v[232:233], v[16:17]
    v_pk_mul_f32 v[234:235], v[234:235], v[18:19]
    v_pk_mul_f32 v[236:237], v[236:237], v[20:21]
    v_pk_mul_f32 v[238:239], v[238:239], v[22:23]
    s_waitcnt vmcnt(18)
    v_lshlrev_b32 v184, 16, v56
    v_and_b32 v185, 0xffff0000, v56
    v_lshlrev_b32 v186, 16, v57
    v_and_b32 v187, 0xffff0000, v57
    v_lshlrev_b32 v188, 16, v58
    v_and_b32 v189, 0xffff0000, v58
    v_lshlrev_b32 v190, 16, v59
    v_and_b32 v191, 0xffff0000, v59
    v_lshlrev_b32 v16, 16, v132
    v_and_b32 v17, 0xffff0000, v132
    v_lshlrev_b32 v18, 16, v133
    v_and_b32 v19, 0xffff0000, v133
    v_lshlrev_b32 v20, 16, v134
    v_and_b32 v21, 0xffff0000, v134
    v_lshlrev_b32 v22, 16, v135
    v_and_b32 v23, 0xffff0000, v135
    buffer_load_dwordx4 v[100:103], v7, s[72:75], s14 offen offset:3072
    buffer_load_dwordx4 v[132:135], v7, s[76:79], s14 offen offset:3072
    s_waitcnt vmcnt(19)
    v_readlane_b32 s89, v249, s4
    v_readlane_b32 s43, v249, s9
    s_min_u32 s92, s89, s43
    s_cmp_eq_u32 s92, 0
    s_cbranch_scc1 L_np_28
L_nd_29:
    v_readlane_b32 s88, v248, s4
    v_readlane_b32 s42, v248, s9
    s_lshl_b32 s91, s28, 24
    s_or_b32 s91, s91, s89
    s_mov_b32 s90, s88
    v_mov_b32 v12, s88
    v_mov_b32 v13, s91
    s_cmp_lg_u32 s3, 0
    s_cbranch_scc1 L_hp_30
    s_lshl_b32 s92, s4, 9
    s_lshl_b32 s93, s5, 3
    s_add_u32 s92, s92, s93
    s_add_u32 s92, s92, 12648448
    s_mov_b64 exec, 1
    buffer_store_dwordx2 v[12:13], v10, s[52:55], s92 offen
    s_mov_b64 exec, -1
L_hp_30:
    v_pk_mul_f32 v[240:241], v[192:193], v[224:225]
    v_pk_mul_f32 v[242:243], v[194:195], v[226:227]
    v_pk_mul_f32 v[244:245], v[196:197], v[228:229]
    v_pk_mul_f32 v[246:247], v[198:199], v[230:231]
    v_pk_fma_f32 v[240:241], v[168:169], v[216:217], v[240:241]
    v_pk_fma_f32 v[242:243], v[170:171], v[218:219], v[242:243]
    v_pk_fma_f32 v[244:245], v[172:173], v[220:221], v[244:245]
    v_pk_fma_f32 v[246:247], v[174:175], v[222:223], v[246:247]
    v_pk_fma_f32 v[240:241], v[176:177], v[208:209], v[240:241]
    v_pk_fma_f32 v[242:243], v[178:179], v[210:211], v[242:243]
    v_pk_fma_f32 v[244:245], v[180:181], v[212:213], v[244:245]
    v_pk_fma_f32 v[246:247], v[182:183], v[214:215], v[246:247]
    v_pk_fma_f32 v[240:241], v[184:185], v[200:201], v[240:241]
    v_pk_fma_f32 v[242:243], v[186:187], v[202:203], v[242:243]
    v_pk_fma_f32 v[244:245], v[188:189], v[204:205], v[244:245]
    v_pk_fma_f32 v[246:247], v[190:191], v[206:207], v[246:247]
    v_pk_mul_f32 v[240:241], v[240:241], v[16:17]
    v_pk_mul_f32 v[242:243], v[242:243], v[18:19]
    v_pk_mul_f32 v[244:245], v[244:245], v[20:21]
    v_pk_mul_f32 v[246:247], v[246:247], v[22:23]
    v_cvt_pk_bf16_f32 v136, v240, v232
    v_cvt_pk_bf16_f32 v140, v241, v233
    v_cvt_pk_bf16_f32 v144, v242, v234
    v_cvt_pk_bf16_f32 v148, v243, v235
    v_cvt_pk_bf16_f32 v152, v244, v236
    v_cvt_pk_bf16_f32 v156, v245, v237
    v_cvt_pk_bf16_f32 v160, v246, v238
    v_cvt_pk_bf16_f32 v164, v247, v239
    ds_write_b128 v8, v[136:139] offset:0
    ds_write_b128 v8, v[140:143] offset:128
    ds_write_b128 v8, v[144:147] offset:256
    ds_write_b128 v8, v[148:151] offset:384
    ds_write_b128 v8, v[152:155] offset:512
    ds_write_b128 v8, v[156:159] offset:640
    ds_write_b128 v8, v[160:163] offset:768
    ds_write_b128 v8, v[164:167] offset:896
    ds_read_b128 v[24:27], v15 offset:0
    ds_read_b128 v[28:31], v15 offset:1024
    ds_read_b128 v[32:35], v15 offset:2048
    ds_read_b128 v[36:39], v15 offset:3072
    ds_read_b128 v[40:43], v15 offset:4096
    ds_read_b128 v[44:47], v15 offset:5120
    ds_read_b128 v[48:51], v15 offset:6144
    ds_read_b128 v[52:55], v15 offset:7168
    s_lshl_b32 s24, s8, 6
    s_lshl_b32 s25, s3, 4
    s_add_u32 s12, s24, s25
    s_lshl_b32 s13, s12, 10
    s_waitcnt vmcnt(18)
    v_lshlrev_b32 v168, 16, v60
    v_and_b32 v169, 0xffff0000, v60
    v_lshlrev_b32 v170, 16, v61
    v_and_b32 v171, 0xffff0000, v61
    v_lshlrev_b32 v172, 16, v62
    v_and_b32 v173, 0xffff0000, v62
    v_lshlrev_b32 v174, 16, v63
    v_and_b32 v175, 0xffff0000, v63
    s_waitcnt vmcnt(17)
    v_lshlrev_b32 v176, 16, v64
    v_and_b32 v177, 0xffff0000, v64
    v_lshlrev_b32 v178, 16, v65
    v_and_b32 v179, 0xffff0000, v65
    v_lshlrev_b32 v180, 16, v66
    v_and_b32 v181, 0xffff0000, v66
    v_lshlrev_b32 v182, 16, v67
    v_and_b32 v183, 0xffff0000, v67
    s_waitcnt vmcnt(16)
    v_lshlrev_b32 v184, 16, v68
    v_and_b32 v185, 0xffff0000, v68
    v_lshlrev_b32 v186, 16, v69
    v_and_b32 v187, 0xffff0000, v69
    v_lshlrev_b32 v188, 16, v70
    v_and_b32 v189, 0xffff0000, v70
    v_lshlrev_b32 v190, 16, v71
    v_and_b32 v191, 0xffff0000, v71
    s_waitcnt vmcnt(14)
    v_lshlrev_b32 v192, 16, v72
    v_and_b32 v193, 0xffff0000, v72
    v_lshlrev_b32 v194, 16, v73
    v_and_b32 v195, 0xffff0000, v73
    v_lshlrev_b32 v196, 16, v74
    v_and_b32 v197, 0xffff0000, v74
    v_lshlrev_b32 v198, 16, v75
    v_and_b32 v199, 0xffff0000, v75
    v_lshlrev_b32 v60, 16, v104
    v_and_b32 v61, 0xffff0000, v104
    v_lshlrev_b32 v62, 16, v105
    v_and_b32 v63, 0xffff0000, v105
    v_lshlrev_b32 v64, 16, v106
    v_and_b32 v65, 0xffff0000, v106
    v_lshlrev_b32 v66, 16, v107
    v_and_b32 v67, 0xffff0000, v107
    s_waitcnt lgkmcnt(7)
    v_xor_b32 v251, 0, v250
    s_add_u32 s24, s11, 0
    buffer_store_dwordx4 v[24:27], v251, s[52:55], s24 offen offset:128 sc1
    buffer_load_dwordx4 a[128:131], v11, s[44:47], s13 offen offset:0
    buffer_load_dwordx4 a[132:135], v11, s[44:47], s13 offen offset:1024
    buffer_load_dwordx4 a[224:227], v11, s[84:87], 0 offen
    v_pk_mul_f32 v[232:233], v[168:169], v[224:225]
    v_pk_mul_f32 v[234:235], v[170:171], v[226:227]
    v_pk_mul_f32 v[236:237], v[172:173], v[228:229]
    v_pk_mul_f32 v[238:239], v[174:175], v[230:231]
    v_pk_fma_f32 v[232:233], v[176:177], v[216:217], v[232:233]
    v_pk_fma_f32 v[234:235], v[178:179], v[218:219], v[234:235]
    v_pk_fma_f32 v[236:237], v[180:181], v[220:221], v[236:237]
    v_pk_fma_f32 v[238:239], v[182:183], v[222:223], v[238:239]
    v_pk_fma_f32 v[232:233], v[184:185], v[208:209], v[232:233]
    v_pk_fma_f32 v[234:235], v[186:187], v[210:211], v[234:235]
    v_pk_fma_f32 v[236:237], v[188:189], v[212:213], v[236:237]
    v_pk_fma_f32 v[238:239], v[190:191], v[214:215], v[238:239]
    v_pk_fma_f32 v[232:233], v[192:193], v[200:201], v[232:233]
    v_pk_fma_f32 v[234:235], v[194:195], v[202:203], v[234:235]
    v_pk_fma_f32 v[236:237], v[196:197], v[204:205], v[236:237]
    v_pk_fma_f32 v[238:239], v[198:199], v[206:207], v[238:239]
    v_pk_mul_f32 v[232:233], v[232:233], v[60:61]
    v_pk_mul_f32 v[234:235], v[234:235], v[62:63]
    v_pk_mul_f32 v[236:237], v[236:237], v[64:65]
    v_pk_mul_f32 v[238:239], v[238:239], v[66:67]
    s_waitcnt vmcnt(16)
    v_lshlrev_b32 v168, 16, v76
    v_and_b32 v169, 0xffff0000, v76
    v_lshlrev_b32 v170, 16, v77
    v_and_b32 v171, 0xffff0000, v77
    v_lshlrev_b32 v172, 16, v78
    v_and_b32 v173, 0xffff0000, v78
    v_lshlrev_b32 v174, 16, v79
    v_and_b32 v175, 0xffff0000, v79
    v_lshlrev_b32 v60, 16, v108
    v_and_b32 v61, 0xffff0000, v108
    v_lshlrev_b32 v62, 16, v109
    v_and_b32 v63, 0xffff0000, v109
    v_lshlrev_b32 v64, 16, v110
    v_and_b32 v65, 0xffff0000, v110
    v_lshlrev_b32 v66, 16, v111
    v_and_b32 v67, 0xffff0000, v111
    s_waitcnt lgkmcnt(6)
    v_xor_b32 v251, 16, v250
    s_add_u32 s24, s11, 32768
    buffer_store_dwordx4 v[28:31], v251, s[52:55], s24 offen offset:128 sc1
    buffer_load_dwordx4 a[136:139], v11, s[44:47], s13 offen offset:2048
    buffer_load_dwordx4 a[140:143], v11, s[44:47], s13 offen offset:3072
    s_add_u32 s13, s13, 4096
    v_pk_mul_f32 v[240:241], v[176:177], v[224:225]
    v_pk_mul_f32 v[242:243], v[178:179], v[226:227]
    v_pk_mul_f32 v[244:245], v[180:181], v[228:229]
    v_pk_mul_f32 v[246:247], v[182:183], v[230:231]
    v_pk_fma_f32 v[240:241], v[184:185], v[216:217], v[240:241]
    v_pk_fma_f32 v[242:243], v[186:187], v[218:219], v[242:243]
    v_pk_fma_f32 v[244:245], v[188:189], v[220:221], v[244:245]
    v_pk_fma_f32 v[246:247], v[190:191], v[222:223], v[246:247]
    v_pk_fma_f32 v[240:241], v[192:193], v[208:209], v[240:241]
    v_pk_fma_f32 v[242:243], v[194:195], v[210:211], v[242:243]
    v_pk_fma_f32 v[244:245], v[196:197], v[212:213], v[244:245]
    v_pk_fma_f32 v[246:247], v[198:199], v[214:215], v[246:247]
    v_pk_fma_f32 v[240:241], v[168:169], v[200:201], v[240:241]
    v_pk_fma_f32 v[242:243], v[170:171], v[202:203], v[242:243]
    v_pk_fma_f32 v[244:245], v[172:173], v[204:205], v[244:245]
    v_pk_fma_f32 v[246:247], v[174:175], v[206:207], v[246:247]
    v_pk_mul_f32 v[240:241], v[240:241], v[60:61]
    v_pk_mul_f32 v[242:243], v[242:243], v[62:63]
    v_pk_mul_f32 v[244:245], v[244:245], v[64:65]
    v_pk_mul_f32 v[246:247], v[246:247], v[66:67]
    v_cvt_pk_bf16_f32 v139, v240, v232
    v_cvt_pk_bf16_f32 v143, v241, v233
    v_cvt_pk_bf16_f32 v147, v242, v234
    v_cvt_pk_bf16_f32 v151, v243, v235
    v_cvt_pk_bf16_f32 v155, v244, v236
    v_cvt_pk_bf16_f32 v159, v245, v237
    v_cvt_pk_bf16_f32 v163, v246, v238
    v_cvt_pk_bf16_f32 v167, v247, v239
    s_waitcnt vmcnt(17)
    v_lshlrev_b32 v176, 16, v80
    v_and_b32 v177, 0xffff0000, v80
    v_lshlrev_b32 v178, 16, v81
    v_and_b32 v179, 0xffff0000, v81
    v_lshlrev_b32 v180, 16, v82
    v_and_b32 v181, 0xffff0000, v82
    v_lshlrev_b32 v182, 16, v83
    v_and_b32 v183, 0xffff0000, v83
    v_lshlrev_b32 v60, 16, v112
    v_and_b32 v61, 0xffff0000, v112
    v_lshlrev_b32 v62, 16, v113
    v_and_b32 v63, 0xffff0000, v113
    v_lshlrev_b32 v64, 16, v114
    v_and_b32 v65, 0xffff0000, v114
    v_lshlrev_b32 v66, 16, v115
    v_and_b32 v67, 0xffff0000, v115
    s_waitcnt lgkmcnt(5)
    v_xor_b32 v251, 32, v250
    s_add_u32 s24, s11, 65536
    buffer_store_dwordx4 v[32:35], v251, s[52:55], s24 offen offset:128 sc1
    buffer_load_dwordx4 a[144:147], v11, s[44:47], s13 offen offset:0
    buffer_load_dwordx4 a[148:151], v11, s[44:47], s13 offen offset:1024
    v_pk_mul_f32 v[232:233], v[184:185], v[224:225]
    v_pk_mul_f32 v[234:235], v[186:187], v[226:227]
    v_pk_mul_f32 v[236:237], v[188:189], v[228:229]
    v_pk_mul_f32 v[238:239], v[190:191], v[230:231]
    v_pk_fma_f32 v[232:233], v[192:193], v[216:217], v[232:233]
    v_pk_fma_f32 v[234:235], v[194:195], v[218:219], v[234:235]
    v_pk_fma_f32 v[236:237], v[196:197], v[220:221], v[236:237]
    v_pk_fma_f32 v[238:239], v[198:199], v[222:223], v[238:239]
    v_pk_fma_f32 v[232:233], v[168:169], v[208:209], v[232:233]
    v_pk_fma_f32 v[234:235], v[170:171], v[210:211], v[234:235]
    v_pk_fma_f32 v[236:237], v[172:173], v[212:213], v[236:237]
    v_pk_fma_f32 v[238:239], v[174:175], v[214:215], v[238:239]
    v_pk_fma_f32 v[232:233], v[176:177], v[200:201], v[232:233]
    v_pk_fma_f32 v[234:235], v[178:179], v[202:203], v[234:235]
    v_pk_fma_f32 v[236:237], v[180:181], v[204:205], v[236:237]
    v_pk_fma_f32 v[238:239], v[182:183], v[206:207], v[238:239]
    v_pk_mul_f32 v[232:233], v[232:233], v[60:61]
    v_pk_mul_f32 v[234:235], v[234:235], v[62:63]
    v_pk_mul_f32 v[236:237], v[236:237], v[64:65]
    v_pk_mul_f32 v[238:239], v[238:239], v[66:67]
    s_waitcnt vmcnt(18)
    v_lshlrev_b32 v184, 16, v84
    v_and_b32 v185, 0xffff0000, v84
    v_lshlrev_b32 v186, 16, v85
    v_and_b32 v187, 0xffff0000, v85
    v_lshlrev_b32 v188, 16, v86
    v_and_b32 v189, 0xffff0000, v86
    v_lshlrev_b32 v190, 16, v87
    v_and_b32 v191, 0xffff0000, v87
    v_lshlrev_b32 v60, 16, v116
    v_and_b32 v61, 0xffff0000, v116
    v_lshlrev_b32 v62, 16, v117
    v_and_b32 v63, 0xffff0000, v117
    v_lshlrev_b32 v64, 16, v118
    v_and_b32 v65, 0xffff0000, v118
    v_lshlrev_b32 v66, 16, v119
    v_and_b32 v67, 0xffff0000, v119
    s_waitcnt lgkmcnt(4)
    v_xor_b32 v251, 48, v250
    s_add_u32 s24, s11, 98304
    buffer_store_dwordx4 v[36:39], v251, s[52:55], s24 offen offset:128 sc1
    buffer_load_dwordx4 a[152:155], v11, s[44:47], s13 offen offset:2048
    buffer_load_dwordx4 a[156:159], v11, s[44:47], s13 offen offset:3072
    s_add_u32 s13, s13, 4096
    v_pk_mul_f32 v[240:241], v[192:193], v[224:225]
    v_pk_mul_f32 v[242:243], v[194:195], v[226:227]
    v_pk_mul_f32 v[244:245], v[196:197], v[228:229]
    v_pk_mul_f32 v[246:247], v[198:199], v[230:231]
    v_pk_fma_f32 v[240:241], v[168:169], v[216:217], v[240:241]
    v_pk_fma_f32 v[242:243], v[170:171], v[218:219], v[242:243]
    v_pk_fma_f32 v[244:245], v[172:173], v[220:221], v[244:245]
    v_pk_fma_f32 v[246:247], v[174:175], v[222:223], v[246:247]
    v_pk_fma_f32 v[240:241], v[176:177], v[208:209], v[240:241]
    v_pk_fma_f32 v[242:243], v[178:179], v[210:211], v[242:243]
    v_pk_fma_f32 v[244:245], v[180:181], v[212:213], v[244:245]
    v_pk_fma_f32 v[246:247], v[182:183], v[214:215], v[246:247]
    v_pk_fma_f32 v[240:241], v[184:185], v[200:201], v[240:241]
    v_pk_fma_f32 v[242:243], v[186:187], v[202:203], v[242:243]
    v_pk_fma_f32 v[244:245], v[188:189], v[204:205], v[244:245]
    v_pk_fma_f32 v[246:247], v[190:191], v[206:207], v[246:247]
    v_pk_mul_f32 v[240:241], v[240:241], v[60:61]
    v_pk_mul_f32 v[242:243], v[242:243], v[62:63]
    v_pk_mul_f32 v[244:245], v[244:245], v[64:65]
    v_pk_mul_f32 v[246:247], v[246:247], v[66:67]
    v_cvt_pk_bf16_f32 v138, v240, v232
    v_cvt_pk_bf16_f32 v142, v241, v233
    v_cvt_pk_bf16_f32 v146, v242, v234
    v_cvt_pk_bf16_f32 v150, v243, v235
    v_cvt_pk_bf16_f32 v154, v244, v236
    v_cvt_pk_bf16_f32 v158, v245, v237
    v_cvt_pk_bf16_f32 v162, v246, v238
    v_cvt_pk_bf16_f32 v166, v247, v239
    s_waitcnt vmcnt(19)
    v_lshlrev_b32 v192, 16, v88
    v_and_b32 v193, 0xffff0000, v88
    v_lshlrev_b32 v194, 16, v89
    v_and_b32 v195, 0xffff0000, v89
    v_lshlrev_b32 v196, 16, v90
    v_and_b32 v197, 0xffff0000, v90
    v_lshlrev_b32 v198, 16, v91
    v_and_b32 v199, 0xffff0000, v91
    v_lshlrev_b32 v60, 16, v120
    v_and_b32 v61, 0xffff0000, v120
    v_lshlrev_b32 v62, 16, v121
    v_and_b32 v63, 0xffff0000, v121
    v_lshlrev_b32 v64, 16, v122
    v_and_b32 v65, 0xffff0000, v122
    v_lshlrev_b32 v66, 16, v123
    v_and_b32 v67, 0xffff0000, v123
    s_waitcnt lgkmcnt(3)
    v_xor_b32 v251, 64, v250
    s_add_u32 s24, s11, 131072
    buffer_store_dwordx4 v[40:43], v251, s[52:55], s24 offen offset:128 sc1
    buffer_load_dwordx4 a[160:163], v11, s[44:47], s13 offen offset:0
    buffer_load_dwordx4 a[164:167], v11, s[44:47], s13 offen offset:1024
    v_pk_mul_f32 v[232:233], v[168:169], v[224:225]
    v_pk_mul_f32 v[234:235], v[170:171], v[226:227]
    v_pk_mul_f32 v[236:237], v[172:173], v[228:229]
    v_pk_mul_f32 v[238:239], v[174:175], v[230:231]
    v_pk_fma_f32 v[232:233], v[176:177], v[216:217], v[232:233]
    v_pk_fma_f32 v[234:235], v[178:179], v[218:219], v[234:235]
    v_pk_fma_f32 v[236:237], v[180:181], v[220:221], v[236:237]
    v_pk_fma_f32 v[238:239], v[182:183], v[222:223], v[238:239]
    v_pk_fma_f32 v[232:233], v[184:185], v[208:209], v[232:233]
    v_pk_fma_f32 v[234:235], v[186:187], v[210:211], v[234:235]
    v_pk_fma_f32 v[236:237], v[188:189], v[212:213], v[236:237]
    v_pk_fma_f32 v[238:239], v[190:191], v[214:215], v[238:239]
    v_pk_fma_f32 v[232:233], v[192:193], v[200:201], v[232:233]
    v_pk_fma_f32 v[234:235], v[194:195], v[202:203], v[234:235]
    v_pk_fma_f32 v[236:237], v[196:197], v[204:205], v[236:237]
    v_pk_fma_f32 v[238:239], v[198:199], v[206:207], v[238:239]
    v_pk_mul_f32 v[232:233], v[232:233], v[60:61]
    v_pk_mul_f32 v[234:235], v[234:235], v[62:63]
    v_pk_mul_f32 v[236:237], v[236:237], v[64:65]
    v_pk_mul_f32 v[238:239], v[238:239], v[66:67]
    s_waitcnt vmcnt(20)
    v_lshlrev_b32 v168, 16, v92
    v_and_b32 v169, 0xffff0000, v92
    v_lshlrev_b32 v170, 16, v93
    v_and_b32 v171, 0xffff0000, v93
    v_lshlrev_b32 v172, 16, v94
    v_and_b32 v173, 0xffff0000, v94
    v_lshlrev_b32 v174, 16, v95
    v_and_b32 v175, 0xffff0000, v95
    v_lshlrev_b32 v60, 16, v124
    v_and_b32 v61, 0xffff0000, v124
    v_lshlrev_b32 v62, 16, v125
    v_and_b32 v63, 0xffff0000, v125
    v_lshlrev_b32 v64, 16, v126
    v_and_b32 v65, 0xffff0000, v126
    v_lshlrev_b32 v66, 16, v127
    v_and_b32 v67, 0xffff0000, v127
    s_waitcnt lgkmcnt(2)
    v_xor_b32 v251, 80, v250
    s_add_u32 s24, s11, 163840
    buffer_store_dwordx4 v[44:47], v251, s[52:55], s24 offen offset:128 sc1
    buffer_load_dwordx4 a[168:171], v11, s[44:47], s13 offen offset:2048
    buffer_load_dwordx4 a[172:175], v11, s[44:47], s13 offen offset:3072
    s_add_u32 s13, s13, 4096
    v_pk_mul_f32 v[240:241], v[176:177], v[224:225]
    v_pk_mul_f32 v[242:243], v[178:179], v[226:227]
    v_pk_mul_f32 v[244:245], v[180:181], v[228:229]
    v_pk_mul_f32 v[246:247], v[182:183], v[230:231]
    v_pk_fma_f32 v[240:241], v[184:185], v[216:217], v[240:241]
    v_pk_fma_f32 v[242:243], v[186:187], v[218:219], v[242:243]
    v_pk_fma_f32 v[244:245], v[188:189], v[220:221], v[244:245]
    v_pk_fma_f32 v[246:247], v[190:191], v[222:223], v[246:247]
    v_pk_fma_f32 v[240:241], v[192:193], v[208:209], v[240:241]
    v_pk_fma_f32 v[242:243], v[194:195], v[210:211], v[242:243]
    v_pk_fma_f32 v[244:245], v[196:197], v[212:213], v[244:245]
    v_pk_fma_f32 v[246:247], v[198:199], v[214:215], v[246:247]
    v_pk_fma_f32 v[240:241], v[168:169], v[200:201], v[240:241]
    v_pk_fma_f32 v[242:243], v[170:171], v[202:203], v[242:243]
    v_pk_fma_f32 v[244:245], v[172:173], v[204:205], v[244:245]
    v_pk_fma_f32 v[246:247], v[174:175], v[206:207], v[246:247]
    v_pk_mul_f32 v[240:241], v[240:241], v[60:61]
    v_pk_mul_f32 v[242:243], v[242:243], v[62:63]
    v_pk_mul_f32 v[244:245], v[244:245], v[64:65]
    v_pk_mul_f32 v[246:247], v[246:247], v[66:67]
    v_cvt_pk_bf16_f32 v137, v240, v232
    v_cvt_pk_bf16_f32 v141, v241, v233
    v_cvt_pk_bf16_f32 v145, v242, v234
    v_cvt_pk_bf16_f32 v149, v243, v235
    v_cvt_pk_bf16_f32 v153, v244, v236
    v_cvt_pk_bf16_f32 v157, v245, v237
    v_cvt_pk_bf16_f32 v161, v246, v238
    v_cvt_pk_bf16_f32 v165, v247, v239
    s_waitcnt vmcnt(21)
    v_lshlrev_b32 v176, 16, v96
    v_and_b32 v177, 0xffff0000, v96
    v_lshlrev_b32 v178, 16, v97
    v_and_b32 v179, 0xffff0000, v97
    v_lshlrev_b32 v180, 16, v98
    v_and_b32 v181, 0xffff0000, v98
    v_lshlrev_b32 v182, 16, v99
    v_and_b32 v183, 0xffff0000, v99
    v_lshlrev_b32 v60, 16, v128
    v_and_b32 v61, 0xffff0000, v128
    v_lshlrev_b32 v62, 16, v129
    v_and_b32 v63, 0xffff0000, v129
    v_lshlrev_b32 v64, 16, v130
    v_and_b32 v65, 0xffff0000, v130
    v_lshlrev_b32 v66, 16, v131
    v_and_b32 v67, 0xffff0000, v131
    s_waitcnt lgkmcnt(1)
    v_xor_b32 v251, 96, v250
    s_add_u32 s24, s11, 196608
    buffer_store_dwordx4 v[48:51], v251, s[52:55], s24 offen offset:128 sc1
    buffer_load_dwordx4 a[176:179], v11, s[44:47], s13 offen offset:0
    buffer_load_dwordx4 a[180:183], v11, s[44:47], s13 offen offset:1024
    v_pk_mul_f32 v[232:233], v[184:185], v[224:225]
    v_pk_mul_f32 v[234:235], v[186:187], v[226:227]
    v_pk_mul_f32 v[236:237], v[188:189], v[228:229]
    v_pk_mul_f32 v[238:239], v[190:191], v[230:231]
    v_pk_fma_f32 v[232:233], v[192:193], v[216:217], v[232:233]
    v_pk_fma_f32 v[234:235], v[194:195], v[218:219], v[234:235]
    v_pk_fma_f32 v[236:237], v[196:197], v[220:221], v[236:237]
    v_pk_fma_f32 v[238:239], v[198:199], v[222:223], v[238:239]
    v_pk_fma_f32 v[232:233], v[168:169], v[208:209], v[232:233]
    v_pk_fma_f32 v[234:235], v[170:171], v[210:211], v[234:235]
    v_pk_fma_f32 v[236:237], v[172:173], v[212:213], v[236:237]
    v_pk_fma_f32 v[238:239], v[174:175], v[214:215], v[238:239]
    v_pk_fma_f32 v[232:233], v[176:177], v[200:201], v[232:233]
    v_pk_fma_f32 v[234:235], v[178:179], v[202:203], v[234:235]
    v_pk_fma_f32 v[236:237], v[180:181], v[204:205], v[236:237]
    v_pk_fma_f32 v[238:239], v[182:183], v[206:207], v[238:239]
    v_pk_mul_f32 v[232:233], v[232:233], v[60:61]
    v_pk_mul_f32 v[234:235], v[234:235], v[62:63]
    v_pk_mul_f32 v[236:237], v[236:237], v[64:65]
    v_pk_mul_f32 v[238:239], v[238:239], v[66:67]
    s_waitcnt vmcnt(22)
    v_lshlrev_b32 v184, 16, v100
    v_and_b32 v185, 0xffff0000, v100
    v_lshlrev_b32 v186, 16, v101
    v_and_b32 v187, 0xffff0000, v101
    v_lshlrev_b32 v188, 16, v102
    v_and_b32 v189, 0xffff0000, v102
    v_lshlrev_b32 v190, 16, v103
    v_and_b32 v191, 0xffff0000, v103
    v_lshlrev_b32 v60, 16, v132
    v_and_b32 v61, 0xffff0000, v132
    v_lshlrev_b32 v62, 16, v133
    v_and_b32 v63, 0xffff0000, v133
    v_lshlrev_b32 v64, 16, v134
    v_and_b32 v65, 0xffff0000, v134
    v_lshlrev_b32 v66, 16, v135
    v_and_b32 v67, 0xffff0000, v135
    s_waitcnt lgkmcnt(0)
    v_xor_b32 v251, 112, v250
    s_add_u32 s24, s11, 229376
    buffer_store_dwordx4 v[52:55], v251, s[52:55], s24 offen offset:128 sc1
    buffer_load_dwordx4 a[184:187], v11, s[44:47], s13 offen offset:2048
    buffer_load_dwordx4 a[188:191], v11, s[44:47], s13 offen offset:3072
    s_add_u32 s13, s13, 4096
    v_pk_mul_f32 v[240:241], v[192:193], v[224:225]
    v_pk_mul_f32 v[242:243], v[194:195], v[226:227]
    v_pk_mul_f32 v[244:245], v[196:197], v[228:229]
    v_pk_mul_f32 v[246:247], v[198:199], v[230:231]
    v_pk_fma_f32 v[240:241], v[168:169], v[216:217], v[240:241]
    v_pk_fma_f32 v[242:243], v[170:171], v[218:219], v[242:243]
    v_pk_fma_f32 v[244:245], v[172:173], v[220:221], v[244:245]
    v_pk_fma_f32 v[246:247], v[174:175], v[222:223], v[246:247]
    v_pk_fma_f32 v[240:241], v[176:177], v[208:209], v[240:241]
    v_pk_fma_f32 v[242:243], v[178:179], v[210:211], v[242:243]
    v_pk_fma_f32 v[244:245], v[180:181], v[212:213], v[244:245]
    v_pk_fma_f32 v[246:247], v[182:183], v[214:215], v[246:247]
    v_pk_fma_f32 v[240:241], v[184:185], v[200:201], v[240:241]
    v_pk_fma_f32 v[242:243], v[186:187], v[202:203], v[242:243]
    v_pk_fma_f32 v[244:245], v[188:189], v[204:205], v[244:245]
    v_pk_fma_f32 v[246:247], v[190:191], v[206:207], v[246:247]
    v_pk_mul_f32 v[240:241], v[240:241], v[60:61]
    v_pk_mul_f32 v[242:243], v[242:243], v[62:63]
    v_pk_mul_f32 v[244:245], v[244:245], v[64:65]
    v_pk_mul_f32 v[246:247], v[246:247], v[66:67]
    v_cvt_pk_bf16_f32 v136, v240, v232
    v_cvt_pk_bf16_f32 v140, v241, v233
    v_cvt_pk_bf16_f32 v144, v242, v234
    v_cvt_pk_bf16_f32 v148, v243, v235
    v_cvt_pk_bf16_f32 v152, v244, v236
    v_cvt_pk_bf16_f32 v156, v245, v237
    v_cvt_pk_bf16_f32 v160, v246, v238
    v_cvt_pk_bf16_f32 v164, v247, v239
    ds_write_b128 v8, v[136:139] offset:8192
    ds_write_b128 v8, v[140:143] offset:8320
    ds_write_b128 v8, v[144:147] offset:8448
    ds_write_b128 v8, v[148:151] offset:8576
    ds_write_b128 v8, v[152:155] offset:8704
    ds_write_b128 v8, v[156:159] offset:8832
    ds_write_b128 v8, v[160:163] offset:8960
    ds_write_b128 v8, v[164:167] offset:9088
    ds_read_b128 v[68:71], v15 offset:8192
    ds_read_b128 v[72:75], v15 offset:9216
    ds_read_b128 v[76:79], v15 offset:10240
    ds_read_b128 v[80:83], v15 offset:11264
    ds_read_b128 v[84:87], v15 offset:12288
    ds_read_b128 v[88:91], v15 offset:13312
    ds_read_b128 v[92:95], v15 offset:14336
    ds_read_b128 v[96:99], v15 offset:15360
    s_waitcnt lgkmcnt(7)
    v_xor_b32 v251, 0, v250
    s_add_u32 s24, s11, 0
    buffer_store_dwordx4 v[68:71], v251, s[52:55], s24 offen offset:0 sc1
    s_waitcnt lgkmcnt(6)
    v_xor_b32 v251, 16, v250
    s_add_u32 s24, s11, 32768
    buffer_store_dwordx4 v[72:75], v251, s[52:55], s24 offen offset:0 sc1
    s_waitcnt lgkmcnt(5)
    v_xor_b32 v251, 32, v250
    s_add_u32 s24, s11, 65536
    buffer_store_dwordx4 v[76:79], v251, s[52:55], s24 offen offset:0 sc1
    s_waitcnt lgkmcnt(4)
    v_xor_b32 v251, 48, v250
    s_add_u32 s24, s11, 98304
    buffer_store_dwordx4 v[80:83], v251, s[52:55], s24 offen offset:0 sc1
    v_lshlrev_b32 v14, 3, v1
    s_lshl_b32 s92, s4, 9
    s_add_u32 s92, s92, 12648448
    buffer_load_dwordx2 v[248:249], v14, s[52:55], s92 offen sc1
    s_waitcnt lgkmcnt(3)
    v_xor_b32 v251, 64, v250
    s_add_u32 s24, s11, 131072
    buffer_store_dwordx4 v[84:87], v251, s[52:55], s24 offen offset:0 sc1
    s_waitcnt lgkmcnt(2)
    v_xor_b32 v251, 80, v250
    s_add_u32 s24, s11, 163840
    buffer_store_dwordx4 v[88:91], v251, s[52:55], s24 offen offset:0 sc1
    s_waitcnt lgkmcnt(1)
    v_xor_b32 v251, 96, v250
    s_add_u32 s24, s11, 196608
    buffer_store_dwordx4 v[92:95], v251, s[52:55], s24 offen offset:0 sc1
    s_waitcnt lgkmcnt(0)
    v_xor_b32 v251, 112, v250
    s_add_u32 s24, s11, 229376
    buffer_store_dwordx4 v[96:99], v251, s[52:55], s24 offen offset:0 sc1
    v_lshrrev_b32 v5, 3, v1
    v_bfe_u32 v6, v1, 1, 2
    v_and_b32 v7, 1, v1
    v_bfe_u32 v8, v5, 1, 1
    v_xor_b32 v6, v6, v8
    v_xor_b32 v8, 2, v6
    v_and_b32 v9, 3, v5
    v_lshrrev_b32 v5, 2, v5
    v_lshl_add_u32 v9, v5, 4, v9
    v_lshlrev_b32 v9, 10, v9
    v_lshl_add_u32 v9, v7, 4, v9
    s_lshl_b32 s25, s9, 7
    s_mul_i32 s24, s3, 458752
    s_add_u32 s25, s25, s24
    v_add_u32 v9, s25, v9
    v_lshl_add_u32 v240, v6, 5, v9
    v_lshl_add_u32 v241, v8, 5, v9
    v_add_u32 v242, 6144, v240
    v_add_u32 v243, 9216, v241
    v_add_u32 v241, 3072, v241
    s_bfe_u32 s79, s5, 0x10001
    s_lshl_b32 s80, s79, 15
    s_xor_b32 s81, s80, 32768
    s_mul_i32 s82, s79, 28672
    s_mul_i32 s83, s79, -57344
    s_add_u32 s83, s83, 28672
    s_add_u32 s24, s4, s9
    s_sub_u32 s25, s24, 7
    s_cselect_b32 s24, s24, s25
    s_sub_u32 s25, s24, 7
    s_cselect_b32 s24, s24, s25
    s_lshl_b32 s72, s24, 10
    s_add_u32 s73, s72, 1024
    s_cmp_eq_u32 s73, 7168
    s_cselect_b32 s73, 0, s73
    s_add_u32 s74, s73, 1024
    s_cmp_eq_u32 s74, 7168
    s_cselect_b32 s74, 0, s74
    s_add_u32 s75, s74, 1024
    s_cmp_eq_u32 s75, 7168
    s_cselect_b32 s75, 0, s75
    s_add_u32 s76, s75, 1024
    s_cmp_eq_u32 s76, 7168
    s_cselect_b32 s76, 0, s76
    s_add_u32 s77, s76, 1024
    s_cmp_eq_u32 s77, 7168
    s_cselect_b32 s77, 0, s77
    s_add_u32 s78, s77, 1024
    s_cmp_eq_u32 s78, 7168
    s_cselect_b32 s78, 0, s78
    s_lshl_b32 s84, s76, 6
    s_or_b32 s84, s84, s81
    s_lshl_b32 s85, s77, 6
    s_or_b32 s85, s85, s81
    s_lshl_b32 s86, s78, 6
    s_or_b32 s86, s86, s81
    v_bfe_u32 v5, v1, 2, 2
    v_lshrrev_b32 v6, 1, v5
    v_and_b32 v7, 1, v4
    v_lshl_add_u32 v6, v7, 1, v6
    v_lshl_add_u32 v5, v4, 3, v5
    v_lshlrev_b32 v5, 7, v5
    v_and_b32 v7, 3, v1
    v_lshl_add_u32 v5, v7, 3, v5
    v_add_u32 v5, s22, v5
    v_xor_b32 v7, 0, v6
    v_lshl_add_u32 v232, v7, 5, v5
    v_add_u32 v236, 0x10000, v232
    v_xor_b32 v7, 1, v6
    v_lshl_add_u32 v233, v7, 5, v5
    v_add_u32 v237, 0x10000, v233
    v_xor_b32 v7, 2, v6
    v_lshl_add_u32 v234, v7, 5, v5
    v_add_u32 v238, 0x10000, v234
    v_xor_b32 v7, 3, v6
    v_lshl_add_u32 v235, v7, 5, v5
    v_add_u32 v239, 0x10000, v235
    s_waitcnt lgkmcnt(0)
    s_barrier
    s_waitcnt vmcnt(4)
    v_cmp_eq_u64 vcc, s[90:91], v[248:249]
    s_mov_b32 s30, 0
    s_cmp_eq_u32 vcc_lo, -1
    s_cbranch_scc0 L_mc_31
L_md_32:
    v_mov_b32 v13, s89
    s_lshl_b32 s92, s4, 7
    s_lshl_b32 s24, s6, 3
    s_add_u32 s92, s92, s24
    s_add_u32 s92, s92, 12652544
    s_waitcnt vmcnt(0)
    s_cmp_lg_u32 s30, 0
    s_cbranch_scc1 L_fs_33
    s_mov_b64 exec, 1
    buffer_store_dwordx2 v[12:13], v10, s[52:55], s92 offen
    s_mov_b64 exec, -1
L_fd_34:
    v_lshlrev_b32 v14, 3, v3
    s_lshl_b32 s93, s4, 7
    s_add_u32 s93, s93, 12652544
    buffer_load_dwordx2 v[248:249], v14, s[52:55], s93 offen sc1
    v_accvgpr_read_b32 v192, a224
    v_accvgpr_read_b32 v193, a225
    s_lshl_b32 s26, s72, 6
    s_add_u32 m0, s22, 98304
    s_or_b32 s26, s26, s80
    buffer_load_dwordx4 v240, s[64:67], s26 offen offset:0 lds
    buffer_load_dwordx4 v241, s[64:67], s26 offen offset:1024 lds
    v_accvgpr_read_b32 v194, a226
    v_accvgpr_read_b32 v195, a227
    v_accvgpr_read_b32 v16, a128
    buffer_load_dwordx4 v242, s[64:67], s26 offen offset:2048 lds
    buffer_load_dwordx4 v243, s[64:67], s26 offen offset:3072 lds
    v_accvgpr_read_b32 v17, a129
    v_accvgpr_read_b32 v18, a130
    s_lshl_b32 s26, s73, 6
    s_add_u32 m0, s22, 32768
    s_or_b32 s26, s26, s80
    buffer_load_dwordx4 v240, s[64:67], s26 offen offset:0 lds
    buffer_load_dwordx4 v241, s[64:67], s26 offen offset:1024 lds
    v_accvgpr_read_b32 v19, a131
    v_accvgpr_read_b32 v20, a132
    v_accvgpr_read_b32 v21, a133
    buffer_load_dwordx4 v242, s[64:67], s26 offen offset:2048 lds
    buffer_load_dwordx4 v243, s[64:67], s26 offen offset:3072 lds
    v_accvgpr_read_b32 v22, a134
    v_accvgpr_read_b32 v23, a135
    v_accvgpr_read_b32 v24, a136
    v_accvgpr_read_b32 v25, a137
    v_accvgpr_read_b32 v26, a138
    v_accvgpr_read_b32 v27, a139
    v_accvgpr_read_b32 v28, a140
    v_accvgpr_read_b32 v29, a141
    v_accvgpr_read_b32 v30, a142
    v_accvgpr_read_b32 v31, a143
    v_accvgpr_read_b32 v32, a144
    v_accvgpr_read_b32 v33, a145
    v_accvgpr_read_b32 v34, a146
    v_accvgpr_read_b32 v35, a147
    v_accvgpr_read_b32 v36, a148
    v_accvgpr_read_b32 v37, a149
    v_accvgpr_read_b32 v38, a150
    v_accvgpr_read_b32 v39, a151
    v_accvgpr_read_b32 v40, a152
    v_accvgpr_read_b32 v41, a153
    v_accvgpr_read_b32 v42, a154
    v_accvgpr_read_b32 v43, a155
    v_accvgpr_read_b32 v44, a156
    v_accvgpr_read_b32 v45, a157
    v_accvgpr_read_b32 v46, a158
    v_accvgpr_read_b32 v47, a159
    v_accvgpr_read_b32 v48, a160
    v_accvgpr_read_b32 v49, a161
    v_accvgpr_read_b32 v50, a162
    v_accvgpr_read_b32 v51, a163
    v_accvgpr_read_b32 v52, a164
    v_accvgpr_read_b32 v53, a165
    v_accvgpr_read_b32 v54, a166
    v_accvgpr_read_b32 v55, a167
    v_accvgpr_read_b32 v56, a168
    v_accvgpr_read_b32 v57, a169
    v_accvgpr_read_b32 v58, a170
    v_accvgpr_read_b32 v59, a171
    v_accvgpr_read_b32 v60, a172
    v_accvgpr_read_b32 v61, a173
    v_accvgpr_read_b32 v62, a174
    v_accvgpr_read_b32 v63, a175
    v_accvgpr_read_b32 v64, a176
    v_accvgpr_read_b32 v65, a177
    v_accvgpr_read_b32 v66, a178
    v_accvgpr_read_b32 v67, a179
    v_accvgpr_read_b32 v68, a180
    v_accvgpr_read_b32 v69, a181
    v_accvgpr_read_b32 v70, a182
    s_lshl_b32 s26, s74, 6
    s_add_u32 m0, s22, 49152
    s_or_b32 s26, s26, s80
    buffer_load_dwordx4 v240, s[64:67], s26 offen offset:0 lds
    buffer_load_dwordx4 v241, s[64:67], s26 offen offset:1024 lds
    s_waitcnt vmcnt(10)
    v_cmp_ne_u64 vcc, s[88:89], v[248:249]
    s_cbranch_vccnz L_pl_35
L_pd_36:
    buffer_load_dwordx4 v242, s[64:67], s26 offen offset:2048 lds
    buffer_load_dwordx4 v243, s[64:67], s26 offen offset:3072 lds
    s_add_u32 m0, s20, s36
    s_add_u32 s38, s37, 0
    buffer_load_dwordx4 v11, s[52:55], s38 offen sc1 lds
    buffer_load_dwordx4 v11, s[52:55], s38 offen offset:1024 sc1 lds
    v_accvgpr_read_b32 v71, a183
    v_accvgpr_read_b32 v72, a184
    v_accvgpr_read_b32 v73, a185
    v_accvgpr_read_b32 v74, a186
    v_accvgpr_read_b32 v75, a187
    v_accvgpr_read_b32 v76, a188
    v_accvgpr_read_b32 v77, a189
    v_accvgpr_read_b32 v78, a190
    v_accvgpr_read_b32 v79, a191
    v_dot2_f32_bf16 v200, v16, v192, 0
    v_dot2_f32_bf16 v201, v20, v192, 0
    v_dot2_f32_bf16 v202, v24, v192, 0
    v_dot2_f32_bf16 v203, v28, v192, 0
    v_dot2_f32_bf16 v204, v32, v192, 0
    v_dot2_f32_bf16 v205, v36, v192, 0
    v_dot2_f32_bf16 v206, v40, v192, 0
    v_dot2_f32_bf16 v207, v44, v192, 0
    v_dot2_f32_bf16 v208, v48, v192, 0
    v_dot2_f32_bf16 v209, v52, v192, 0
    v_dot2_f32_bf16 v210, v56, v192, 0
    v_dot2_f32_bf16 v211, v60, v192, 0
    v_dot2_f32_bf16 v212, v64, v192, 0
    v_dot2_f32_bf16 v213, v68, v192, 0
    v_dot2_f32_bf16 v214, v72, v192, 0
    v_dot2_f32_bf16 v215, v76, v192, 0
    v_dot2_f32_bf16 v200, v17, v193, v200
    v_dot2_f32_bf16 v201, v21, v193, v201
    v_dot2_f32_bf16 v202, v25, v193, v202
    v_dot2_f32_bf16 v203, v29, v193, v203
    v_dot2_f32_bf16 v204, v33, v193, v204
    v_dot2_f32_bf16 v205, v37, v193, v205
    v_dot2_f32_bf16 v206, v41, v193, v206
    v_dot2_f32_bf16 v207, v45, v193, v207
    v_dot2_f32_bf16 v208, v49, v193, v208
    v_dot2_f32_bf16 v209, v53, v193, v209
    v_dot2_f32_bf16 v210, v57, v193, v210
    v_dot2_f32_bf16 v211, v61, v193, v211
    v_dot2_f32_bf16 v212, v65, v193, v212
    v_dot2_f32_bf16 v213, v69, v193, v213
    v_dot2_f32_bf16 v214, v73, v193, v214
    v_dot2_f32_bf16 v215, v77, v193, v215
    v_dot2_f32_bf16 v200, v18, v194, v200
    v_dot2_f32_bf16 v201, v22, v194, v201
    v_dot2_f32_bf16 v202, v26, v194, v202
    v_dot2_f32_bf16 v203, v30, v194, v203
    v_dot2_f32_bf16 v204, v34, v194, v204
    v_dot2_f32_bf16 v205, v38, v194, v205
    v_dot2_f32_bf16 v206, v42, v194, v206
    v_dot2_f32_bf16 v207, v46, v194, v207
    v_dot2_f32_bf16 v208, v50, v194, v208
    v_dot2_f32_bf16 v209, v54, v194, v209
    v_dot2_f32_bf16 v210, v58, v194, v210
    v_dot2_f32_bf16 v211, v62, v194, v211
    v_dot2_f32_bf16 v212, v66, v194, v212
    v_dot2_f32_bf16 v213, v70, v194, v213
    s_lshl_b32 s26, s75, 6
    s_add_u32 m0, s22, 65536
    s_or_b32 s26, s26, s80
    buffer_load_dwordx4 v240, s[64:67], s26 offen offset:0 lds
    buffer_load_dwordx4 v241, s[64:67], s26 offen offset:1024 lds
    s_waitcnt vmcnt(12)
    ds_read_b64_tr_b16 v[80:81], v236 offset:32768
    ds_read_b64_tr_b16 v[82:83], v236 offset:33280
    ds_read_b64_tr_b16 v[84:85], v237 offset:32768
    ds_read_b64_tr_b16 v[86:87], v237 offset:33280
    ds_read_b64_tr_b16 v[88:89], v238 offset:32768
    ds_read_b64_tr_b16 v[90:91], v238 offset:33280
    ds_read_b64_tr_b16 v[92:93], v239 offset:32768
    ds_read_b64_tr_b16 v[94:95], v239 offset:33280
    v_dot2_f32_bf16 v214, v74, v194, v214
    v_dot2_f32_bf16 v215, v78, v194, v215
    v_dot2_f32_bf16 v200, v19, v195, v200
    v_dot2_f32_bf16 v201, v23, v195, v201
    v_dot2_f32_bf16 v202, v27, v195, v202
    v_dot2_f32_bf16 v203, v31, v195, v203
    v_dot2_f32_bf16 v204, v35, v195, v204
    v_dot2_f32_bf16 v205, v39, v195, v205
    v_dot2_f32_bf16 v206, v43, v195, v206
    v_dot2_f32_bf16 v207, v47, v195, v207
    v_dot2_f32_bf16 v208, v51, v195, v208
    v_dot2_f32_bf16 v209, v55, v195, v209
    v_dot2_f32_bf16 v210, v59, v195, v210
    v_dot2_f32_bf16 v211, v63, v195, v211
    v_dot2_f32_bf16 v212, v67, v195, v212
    v_dot2_f32_bf16 v213, v71, v195, v213
    v_dot2_f32_bf16 v214, v75, v195, v214
    v_dot2_f32_bf16 v215, v79, v195, v215
    v_add_f32_dpp v200, v200, v200 row_shr:1 row_mask:0xf bank_mask:0xf bound_ctrl:0
    buffer_load_dwordx4 v242, s[64:67], s26 offen offset:2048 lds
    buffer_load_dwordx4 v243, s[64:67], s26 offen offset:3072 lds
    v_add_f32_dpp v201, v201, v201 row_shr:1 row_mask:0xf bank_mask:0xf bound_ctrl:0
    v_add_f32_dpp v202, v202, v202 row_shr:1 row_mask:0xf bank_mask:0xf bound_ctrl:0
    v_add_f32_dpp v203, v203, v203 row_shr:1 row_mask:0xf bank_mask:0xf bound_ctrl:0
    v_add_f32_dpp v204, v204, v204 row_shr:1 row_mask:0xf bank_mask:0xf bound_ctrl:0
    v_add_f32_dpp v205, v205, v205 row_shr:1 row_mask:0xf bank_mask:0xf bound_ctrl:0
    v_add_f32_dpp v206, v206, v206 row_shr:1 row_mask:0xf bank_mask:0xf bound_ctrl:0
    v_add_f32_dpp v207, v207, v207 row_shr:1 row_mask:0xf bank_mask:0xf bound_ctrl:0
    v_add_f32_dpp v208, v208, v208 row_shr:1 row_mask:0xf bank_mask:0xf bound_ctrl:0
    v_add_f32_dpp v209, v209, v209 row_shr:1 row_mask:0xf bank_mask:0xf bound_ctrl:0
    v_add_f32_dpp v210, v210, v210 row_shr:1 row_mask:0xf bank_mask:0xf bound_ctrl:0
    v_add_f32_dpp v211, v211, v211 row_shr:1 row_mask:0xf bank_mask:0xf bound_ctrl:0
    v_add_f32_dpp v212, v212, v212 row_shr:1 row_mask:0xf bank_mask:0xf bound_ctrl:0
    v_add_f32_dpp v213, v213, v213 row_shr:1 row_mask:0xf bank_mask:0xf bound_ctrl:0
    v_add_f32_dpp v214, v214, v214 row_shr:1 row_mask:0xf bank_mask:0xf bound_ctrl:0
    v_add_f32_dpp v215, v215, v215 row_shr:1 row_mask:0xf bank_mask:0xf bound_ctrl:0
    v_add_f32_dpp v200, v200, v200 row_shr:2 row_mask:0xf bank_mask:0xf bound_ctrl:0
    v_add_f32_dpp v201, v201, v201 row_shr:2 row_mask:0xf bank_mask:0xf bound_ctrl:0
    v_add_f32_dpp v202, v202, v202 row_shr:2 row_mask:0xf bank_mask:0xf bound_ctrl:0
    v_add_f32_dpp v203, v203, v203 row_shr:2 row_mask:0xf bank_mask:0xf bound_ctrl:0
    v_add_f32_dpp v204, v204, v204 row_shr:2 row_mask:0xf bank_mask:0xf bound_ctrl:0
    v_add_f32_dpp v205, v205, v205 row_shr:2 row_mask:0xf bank_mask:0xf bound_ctrl:0
    v_add_f32_dpp v206, v206, v206 row_shr:2 row_mask:0xf bank_mask:0xf bound_ctrl:0
    v_add_f32_dpp v207, v207, v207 row_shr:2 row_mask:0xf bank_mask:0xf bound_ctrl:0
    v_add_f32_dpp v208, v208, v208 row_shr:2 row_mask:0xf bank_mask:0xf bound_ctrl:0
    v_add_f32_dpp v209, v209, v209 row_shr:2 row_mask:0xf bank_mask:0xf bound_ctrl:0
    v_add_f32_dpp v210, v210, v210 row_shr:2 row_mask:0xf bank_mask:0xf bound_ctrl:0
    v_add_f32_dpp v211, v211, v211 row_shr:2 row_mask:0xf bank_mask:0xf bound_ctrl:0
    v_add_f32_dpp v212, v212, v212 row_shr:2 row_mask:0xf bank_mask:0xf bound_ctrl:0
    v_add_f32_dpp v213, v213, v213 row_shr:2 row_mask:0xf bank_mask:0xf bound_ctrl:0
    v_add_f32_dpp v214, v214, v214 row_shr:2 row_mask:0xf bank_mask:0xf bound_ctrl:0
    v_add_f32_dpp v215, v215, v215 row_shr:2 row_mask:0xf bank_mask:0xf bound_ctrl:0
    v_add_f32_dpp v200, v200, v200 row_shr:4 row_mask:0xf bank_mask:0xf bound_ctrl:0
    v_add_f32_dpp v201, v201, v201 row_shr:4 row_mask:0xf bank_mask:0xf bound_ctrl:0
    v_add_f32_dpp v202, v202, v202 row_shr:4 row_mask:0xf bank_mask:0xf bound_ctrl:0
    v_add_f32_dpp v203, v203, v203 row_shr:4 row_mask:0xf bank_mask:0xf bound_ctrl:0
    v_add_f32_dpp v204, v204, v204 row_shr:4 row_mask:0xf bank_mask:0xf bound_ctrl:0
    v_add_f32_dpp v205, v205, v205 row_shr:4 row_mask:0xf bank_mask:0xf bound_ctrl:0
    v_add_f32_dpp v206, v206, v206 row_shr:4 row_mask:0xf bank_mask:0xf bound_ctrl:0
    v_add_f32_dpp v207, v207, v207 row_shr:4 row_mask:0xf bank_mask:0xf bound_ctrl:0
    v_add_f32_dpp v208, v208, v208 row_shr:4 row_mask:0xf bank_mask:0xf bound_ctrl:0
    s_lshl_b32 s26, s76, 6
    s_add_u32 m0, s22, 81920
    s_or_b32 s26, s26, s80
    buffer_load_dwordx4 v240, s[64:67], s26 offen offset:0 lds
    buffer_load_dwordx4 v241, s[64:67], s26 offen offset:1024 lds
    s_waitcnt vmcnt(12)
    ds_read_b64_tr_b16 v[96:97], v232 offset:32768
    ds_read_b64_tr_b16 v[98:99], v232 offset:33280
    ds_read_b64_tr_b16 v[100:101], v233 offset:32768
    ds_read_b64_tr_b16 v[102:103], v233 offset:33280
    ds_read_b64_tr_b16 v[104:105], v234 offset:32768
    ds_read_b64_tr_b16 v[106:107], v234 offset:33280
    ds_read_b64_tr_b16 v[108:109], v235 offset:32768
    ds_read_b64_tr_b16 v[110:111], v235 offset:33280
    v_add_f32_dpp v209, v209, v209 row_shr:4 row_mask:0xf bank_mask:0xf bound_ctrl:0
    v_add_f32_dpp v210, v210, v210 row_shr:4 row_mask:0xf bank_mask:0xf bound_ctrl:0
    v_add_f32_dpp v211, v211, v211 row_shr:4 row_mask:0xf bank_mask:0xf bound_ctrl:0
    v_add_f32_dpp v212, v212, v212 row_shr:4 row_mask:0xf bank_mask:0xf bound_ctrl:0
    v_add_f32_dpp v213, v213, v213 row_shr:4 row_mask:0xf bank_mask:0xf bound_ctrl:0
    v_add_f32_dpp v214, v214, v214 row_shr:4 row_mask:0xf bank_mask:0xf bound_ctrl:0
    v_add_f32_dpp v215, v215, v215 row_shr:4 row_mask:0xf bank_mask:0xf bound_ctrl:0
    v_add_f32_dpp v200, v200, v200 row_shr:8 row_mask:0xf bank_mask:0xf bound_ctrl:0
    v_add_f32_dpp v201, v201, v201 row_shr:8 row_mask:0xf bank_mask:0xf bound_ctrl:0
    v_add_f32_dpp v202, v202, v202 row_shr:8 row_mask:0xf bank_mask:0xf bound_ctrl:0
    v_add_f32_dpp v203, v203, v203 row_shr:8 row_mask:0xf bank_mask:0xf bound_ctrl:0
    v_add_f32_dpp v204, v204, v204 row_shr:8 row_mask:0xf bank_mask:0xf bound_ctrl:0
    v_add_f32_dpp v205, v205, v205 row_shr:8 row_mask:0xf bank_mask:0xf bound_ctrl:0
    v_add_f32_dpp v206, v206, v206 row_shr:8 row_mask:0xf bank_mask:0xf bound_ctrl:0
    v_add_f32_dpp v207, v207, v207 row_shr:8 row_mask:0xf bank_mask:0xf bound_ctrl:0
    v_add_f32_dpp v208, v208, v208 row_shr:8 row_mask:0xf bank_mask:0xf bound_ctrl:0
    v_add_f32_dpp v209, v209, v209 row_shr:8 row_mask:0xf bank_mask:0xf bound_ctrl:0
    v_add_f32_dpp v210, v210, v210 row_shr:8 row_mask:0xf bank_mask:0xf bound_ctrl:0
    v_add_f32_dpp v211, v211, v211 row_shr:8 row_mask:0xf bank_mask:0xf bound_ctrl:0
    v_add_f32_dpp v212, v212, v212 row_shr:8 row_mask:0xf bank_mask:0xf bound_ctrl:0
    v_add_f32_dpp v213, v213, v213 row_shr:8 row_mask:0xf bank_mask:0xf bound_ctrl:0
    v_add_f32_dpp v214, v214, v214 row_shr:8 row_mask:0xf bank_mask:0xf bound_ctrl:0
    v_add_f32_dpp v215, v215, v215 row_shr:8 row_mask:0xf bank_mask:0xf bound_ctrl:0
    buffer_load_dwordx4 v242, s[64:67], s26 offen offset:2048 lds
    buffer_load_dwordx4 v243, s[64:67], s26 offen offset:3072 lds
    v_add_f32_dpp v200, v200, v200 row_bcast:15 row_mask:0xa bank_mask:0xf
    v_add_f32_dpp v201, v201, v201 row_bcast:15 row_mask:0xa bank_mask:0xf
    v_add_f32_dpp v202, v202, v202 row_bcast:15 row_mask:0xa bank_mask:0xf
    v_add_f32_dpp v203, v203, v203 row_bcast:15 row_mask:0xa bank_mask:0xf
    v_add_f32_dpp v204, v204, v204 row_bcast:15 row_mask:0xa bank_mask:0xf
    v_add_f32_dpp v205, v205, v205 row_bcast:15 row_mask:0xa bank_mask:0xf
    v_add_f32_dpp v206, v206, v206 row_bcast:15 row_mask:0xa bank_mask:0xf
    v_add_f32_dpp v207, v207, v207 row_bcast:15 row_mask:0xa bank_mask:0xf
    v_add_f32_dpp v208, v208, v208 row_bcast:15 row_mask:0xa bank_mask:0xf
    v_add_f32_dpp v209, v209, v209 row_bcast:15 row_mask:0xa bank_mask:0xf
    v_add_f32_dpp v210, v210, v210 row_bcast:15 row_mask:0xa bank_mask:0xf
    v_add_f32_dpp v211, v211, v211 row_bcast:15 row_mask:0xa bank_mask:0xf
    v_add_f32_dpp v212, v212, v212 row_bcast:15 row_mask:0xa bank_mask:0xf
    v_add_f32_dpp v213, v213, v213 row_bcast:15 row_mask:0xa bank_mask:0xf
    v_add_f32_dpp v214, v214, v214 row_bcast:15 row_mask:0xa bank_mask:0xf
    v_add_f32_dpp v215, v215, v215 row_bcast:15 row_mask:0xa bank_mask:0xf
    v_add_f32_dpp v200, v200, v200 row_bcast:31 row_mask:0xc bank_mask:0xf
    v_add_f32_dpp v201, v201, v201 row_bcast:31 row_mask:0xc bank_mask:0xf
    v_add_f32_dpp v202, v202, v202 row_bcast:31 row_mask:0xc bank_mask:0xf
    v_add_f32_dpp v203, v203, v203 row_bcast:31 row_mask:0xc bank_mask:0xf
    v_add_f32_dpp v204, v204, v204 row_bcast:31 row_mask:0xc bank_mask:0xf
    v_add_f32_dpp v205, v205, v205 row_bcast:31 row_mask:0xc bank_mask:0xf
    v_add_f32_dpp v206, v206, v206 row_bcast:31 row_mask:0xc bank_mask:0xf
    v_add_f32_dpp v207, v207, v207 row_bcast:31 row_mask:0xc bank_mask:0xf
    v_add_f32_dpp v208, v208, v208 row_bcast:31 row_mask:0xc bank_mask:0xf
    v_add_f32_dpp v209, v209, v209 row_bcast:31 row_mask:0xc bank_mask:0xf
    v_add_f32_dpp v210, v210, v210 row_bcast:31 row_mask:0xc bank_mask:0xf
    v_add_f32_dpp v211, v211, v211 row_bcast:31 row_mask:0xc bank_mask:0xf
    v_add_f32_dpp v212, v212, v212 row_bcast:31 row_mask:0xc bank_mask:0xf
    v_add_f32_dpp v213, v213, v213 row_bcast:31 row_mask:0xc bank_mask:0xf
    v_add_f32_dpp v214, v214, v214 row_bcast:31 row_mask:0xc bank_mask:0xf
    v_add_f32_dpp v215, v215, v215 row_bcast:31 row_mask:0xc bank_mask:0xf
    v_readlane_b32 s24, v200, 63
    v_readlane_b32 s25, v201, 63
    s_nop 2
    v_writelane_b32 v6, s24, 0
    v_writelane_b32 v6, s25, 1
    s_lshl_b32 s26, s77, 6
    s_add_u32 m0, s22, 0
    s_or_b32 s26, s26, s80
    buffer_load_dwordx4 v240, s[64:67], s26 offen offset:0 lds
    buffer_load_dwordx4 v241, s[64:67], s26 offen offset:1024 lds
    s_waitcnt vmcnt(12)
    ds_read_b64_tr_b16 v[112:113], v232 offset:49152
    ds_read_b64_tr_b16 v[114:115], v232 offset:49664
    ds_read_b64_tr_b16 v[116:117], v233 offset:49152
    ds_read_b64_tr_b16 v[118:119], v233 offset:49664
    ds_read_b64_tr_b16 v[120:121], v234 offset:49152
    ds_read_b64_tr_b16 v[122:123], v234 offset:49664
    ds_read_b64_tr_b16 v[124:125], v235 offset:49152
    ds_read_b64_tr_b16 v[126:127], v235 offset:49664
    v_readlane_b32 s24, v202, 63
    v_readlane_b32 s25, v203, 63
    s_nop 2
    v_writelane_b32 v6, s24, 2
    v_writelane_b32 v6, s25, 3
    v_readlane_b32 s24, v204, 63
    v_readlane_b32 s25, v205, 63
    s_nop 2
    v_writelane_b32 v6, s24, 4
    v_writelane_b32 v6, s25, 5
    v_readlane_b32 s24, v206, 63
    v_readlane_b32 s25, v207, 63
    s_nop 2
    v_writelane_b32 v6, s24, 6
    v_writelane_b32 v6, s25, 7
    v_readlane_b32 s24, v208, 63
    v_readlane_b32 s25, v209, 63
    s_nop 2
    v_writelane_b32 v6, s24, 8
    v_writelane_b32 v6, s25, 9
    v_readlane_b32 s24, v210, 63
    v_readlane_b32 s25, v211, 63
    s_nop 2
    v_writelane_b32 v6, s24, 10
    v_writelane_b32 v6, s25, 11
    v_readlane_b32 s24, v212, 63
    v_readlane_b32 s25, v213, 63
    s_nop 2
    v_writelane_b32 v6, s24, 12
    v_writelane_b32 v6, s25, 13
    v_readlane_b32 s24, v214, 63
    v_readlane_b32 s25, v215, 63
    s_nop 2
    v_writelane_b32 v6, s24, 14
    v_writelane_b32 v6, s25, 15
    v_cvt_pk_bf16_f32 v6, v6, v6
    v_lshlrev_b32 v6, 16, v6
    v_mul_f32 v6, 0xbfb8aa3b, v6
    v_exp_f32 v6, v6
    s_lshl_b32 s12, s12, 3
    v_add_f32 v6, 1.0, v6
    v_rcp_f32 v6, v6
    s_add_u32 s12, s12, 12582912
    v_cvt_pk_bf16_f32 v6, v6, v6
    v_lshlrev_b32 v6, 16, v6
    v_mov_b32 v7, s88
    v_lshlrev_b32 v5, 3, v1
    s_mov_b64 exec, 0xffff
    buffer_store_dwordx2 v[6:7], v5, s[52:55], s12 offen sc1
    s_mov_b64 exec, -1
    v_add_u32 v5, 1, v3
    v_and_b32 v6, 3, v5
    v_sub_u32 v5, v5, v6
    v_mul_u32_u24 v6, 4160, v6
    v_lshl_add_u32 v250, v5, 1, v6
    v_lshl_add_u32 v250, v4, 4, v250
    s_lshl_b32 s38, s33, 8
    s_add_u32 s24, s18, s38
    v_add_u32 v250, s24, v250
    v_lshlrev_b32 v5, 5, v3
    v_lshlrev_b32 v6, 4, v4
    v_sub_u32 v251, v6, v5
    s_add_u32 s24, s20, s38
    s_add_u32 s24, s24, 480
    v_add_u32 v251, s24, v251
    s_mul_i32 s24, s3, 7168
    s_add_u32 s24, s24, 2097152
    s_lshl_b32 s34, s8, 2
    s_add_u32 s25, s3, 0
    s_and_b32 s25, s25, 3
    s_add_u32 s25, s25, s34
    s_mul_i32 s25, s25, 57344
    s_add_u32 s25, s25, s24
    v_add_u32 v244, s25, v11
    buffer_load_dwordx4 v242, s[64:67], s26 offen offset:2048 lds
    buffer_load_dwordx4 v243, s[64:67], s26 offen offset:3072 lds
    s_add_u32 s25, s3, 1
    s_and_b32 s25, s25, 3
    s_add_u32 s25, s25, s34
    s_mul_i32 s25, s25, 57344
    s_add_u32 s25, s25, s24
    v_add_u32 v245, s25, v11
    s_add_u32 s25, s3, 2
    s_and_b32 s25, s25, 3
    s_add_u32 s25, s25, s34
    s_mul_i32 s25, s25, 57344
    s_add_u32 s25, s25, s24
    v_add_u32 v246, s25, v11
    s_add_u32 s25, s3, 3
    s_and_b32 s25, s25, 3
    s_add_u32 s25, s25, s34
    s_mul_i32 s25, s25, 57344
    s_add_u32 s25, s25, s24
    v_add_u32 v247, s25, v11
    s_lshl_b32 s26, s78, 6
    s_add_u32 m0, s22, 16384
    s_or_b32 s26, s26, s80
    buffer_load_dwordx4 v240, s[64:67], s26 offen offset:0 lds
    s_waitcnt vmcnt(14)
    s_barrier
    ds_read_b64 a[0:1], v250 offset:0
    ds_read_b64 a[2:3], v250 offset:8
    ds_read_b128 a[32:35], v251 offset:3584
    ds_read_b64 a[4:5], v250 offset:512
    ds_read_b64 a[6:7], v250 offset:520
    ds_read_b128 a[36:39], v251 offset:3072
    ds_read_b64 a[8:9], v250 offset:1024
    ds_read_b64 a[10:11], v250 offset:1032
    ds_read_b128 a[40:43], v251 offset:2560
    ds_read_b64 a[12:13], v250 offset:1536
    ds_read_b64 a[14:15], v250 offset:1544
    ds_read_b128 a[44:47], v251 offset:2048
    ds_read_b64 a[16:17], v250 offset:2048
    ds_read_b64 a[18:19], v250 offset:2056
    ds_read_b128 a[48:51], v251 offset:1536
    ds_read_b64 a[20:21], v250 offset:2560
    ds_read_b64 a[22:23], v250 offset:2568
    ds_read_b128 a[52:55], v251 offset:1024
    ds_read_b64 a[24:25], v250 offset:3072
    ds_read_b64 a[26:27], v250 offset:3080
    ds_read_b128 a[56:59], v251 offset:512
    ds_read_b64 a[28:29], v250 offset:3584
    ds_read_b64 a[30:31], v250 offset:3592
    ds_read_b128 a[60:63], v251 offset:0
    s_waitcnt lgkmcnt(15)
    v_mfma_f32_16x16x32_bf16 v[192:195], a[0:3], a[32:35], 0
    buffer_load_dwordx4 v241, s[64:67], s26 offen offset:1024 lds
    v_mfma_f32_16x16x32_bf16 v[196:199], a[0:3], a[36:39], 0
    v_mfma_f32_16x16x32_bf16 v[196:199], a[4:7], a[32:35], v[196:199]
    s_waitcnt vmcnt(11)
    ds_read_b64_tr_b16 v[128:129], v236 offset:0
    buffer_load_dwordx4 v242, s[64:67], s26 offen offset:2048 lds
    v_mfma_f32_16x16x32_bf16 v[200:203], a[4:7], a[36:39], 0
    ds_read_b64_tr_b16 v[130:131], v236 offset:512
    v_mfma_f32_16x16x32_bf16 v[200:203], a[0:3], a[40:43], v[200:203]
    ds_read_b64_tr_b16 v[132:133], v237 offset:0
    buffer_load_dwordx4 v243, s[64:67], s26 offen offset:3072 lds
    v_mfma_f32_16x16x32_bf16 v[200:203], a[8:11], a[32:35], v[200:203]
    ds_read_b64_tr_b16 v[134:135], v237 offset:512
    v_mfma_f32_16x16x32_bf16 v[204:207], a[4:7], a[40:43], 0
    ds_read_b64_tr_b16 v[136:137], v238 offset:0
    v_mfma_f32_16x16x32_bf16 v[204:207], a[8:11], a[36:39], v[204:207]
    ds_read_b64_tr_b16 v[138:139], v238 offset:512
    v_mfma_f32_16x16x32_bf16 v[208:211], a[8:11], a[40:43], 0
    ds_read_b64_tr_b16 v[140:141], v239 offset:0
    s_waitcnt lgkmcnt(15)
    v_mfma_f32_16x16x32_bf16 v[204:207], a[0:3], a[44:47], v[204:207]
    ds_read_b64_tr_b16 v[142:143], v239 offset:512
    v_mfma_f32_16x16x32_bf16 v[204:207], a[12:15], a[32:35], v[204:207]
    s_lshl_b32 s26, s72, 6
    s_add_u32 m0, s22, 98304
    s_or_b32 s26, s26, s81
    buffer_load_dwordx4 v240, s[64:67], s26 offen offset:0 lds
    v_mfma_f32_16x16x32_bf16 v[208:211], a[4:7], a[44:47], v[208:211]
    ds_read_b64 a[64:65], v250 offset:64
    v_mfma_f32_16x16x32_bf16 v[208:211], a[12:15], a[36:39], v[208:211]
    ds_read_b64 a[66:67], v250 offset:72
    v_mfma_f32_16x16x32_bf16 v[212:215], a[8:11], a[44:47], 0
    buffer_load_dwordx4 v241, s[64:67], s26 offen offset:1024 lds
    v_mfma_f32_16x16x32_bf16 v[212:215], a[12:15], a[40:43], v[212:215]
    ds_read_b128 a[96:99], v251 offset:3648
    v_mfma_f32_16x16x32_bf16 v[216:219], a[12:15], a[44:47], 0
    ds_read_b64 a[68:69], v250 offset:576
    v_mfma_f32_16x16x32_bf16 v[208:211], a[0:3], a[48:51], v[208:211]
    ds_read_b64 a[70:71], v250 offset:584
    v_mfma_f32_16x16x32_bf16 v[208:211], a[16:19], a[32:35], v[208:211]
    ds_read_b128 a[100:103], v251 offset:3136
    v_mfma_f32_16x16x32_bf16 v[212:215], a[4:7], a[48:51], v[212:215]
    ds_read_b64 a[72:73], v250 offset:1088
    buffer_load_dwordx4 v242, s[64:67], s26 offen offset:2048 lds
    v_mfma_f32_16x16x32_bf16 v[212:215], a[16:19], a[36:39], v[212:215]
    s_waitcnt vmcnt(12)
    ds_read_b64_tr_b16 v[144:145], v236 offset:16384
    v_mfma_f32_16x16x32_bf16 v[216:219], a[8:11], a[48:51], v[216:219]
    ds_read_b64_tr_b16 v[146:147], v236 offset:16896
    v_mfma_f32_16x16x32_bf16 v[216:219], a[16:19], a[40:43], v[216:219]
    ds_read_b64_tr_b16 v[148:149], v237 offset:16384
    v_mfma_f32_16x16x32_bf16 v[220:223], a[12:15], a[48:51], 0
    ds_read_b64_tr_b16 v[150:151], v237 offset:16896
    v_mfma_f32_16x16x32_bf16 v[220:223], a[16:19], a[44:47], v[220:223]
    ds_read_b64_tr_b16 v[152:153], v238 offset:16384
    s_waitcnt lgkmcnt(15)
    v_mfma_f32_16x16x32_bf16 v[212:215], a[0:3], a[52:55], v[212:215]
    ds_read_b64_tr_b16 v[154:155], v238 offset:16896
    buffer_load_dwordx4 v243, s[64:67], s26 offen offset:3072 lds
    v_mfma_f32_16x16x32_bf16 v[212:215], a[20:23], a[32:35], v[212:215]
    ds_read_b64_tr_b16 v[156:157], v239 offset:16384
    v_mfma_f32_16x16x32_bf16 v[216:219], a[4:7], a[52:55], v[216:219]
    ds_read_b64_tr_b16 v[158:159], v239 offset:16896
    v_mfma_f32_16x16x32_bf16 v[216:219], a[20:23], a[36:39], v[216:219]
    ds_read_b64 a[74:75], v250 offset:1096
    v_mfma_f32_16x16x32_bf16 v[220:223], a[8:11], a[52:55], v[220:223]
    s_lshl_b32 s26, s73, 6
    s_add_u32 m0, s22, 32768
    s_or_b32 s26, s26, s81
    buffer_load_dwordx4 v240, s[64:67], s26 offen offset:0 lds
    v_mfma_f32_16x16x32_bf16 v[220:223], a[20:23], a[40:43], v[220:223]
    ds_read_b128 a[104:107], v251 offset:2624
    v_mfma_f32_16x16x32_bf16 v[216:219], a[0:3], a[56:59], v[216:219]
    ds_read_b64 a[76:77], v250 offset:1600
    v_mfma_f32_16x16x32_bf16 v[216:219], a[24:27], a[32:35], v[216:219]
    ds_read_b64 a[78:79], v250 offset:1608
    v_mfma_f32_16x16x32_bf16 v[220:223], a[4:7], a[56:59], v[220:223]
    ds_read_b128 a[108:111], v251 offset:2112
    v_mfma_f32_16x16x32_bf16 v[220:223], a[24:27], a[36:39], v[220:223]
    ds_read_b64 a[80:81], v250 offset:2112
    v_mfma_f32_16x16x32_bf16 v[220:223], a[0:3], a[60:63], v[220:223]
    ds_read_b64 a[82:83], v250 offset:2120
    v_mfma_f32_16x16x32_bf16 v[220:223], a[28:31], a[32:35], v[220:223]
    ds_read_b128 a[112:115], v251 offset:1600
    ds_read_b64 a[84:85], v250 offset:2624
    ds_read_b64 a[86:87], v250 offset:2632
    ds_read_b128 a[116:119], v251 offset:1088
    ds_read_b64 a[88:89], v250 offset:3136
    ds_read_b64 a[90:91], v250 offset:3144
    ds_read_b128 a[120:123], v251 offset:576
    ds_read_b64 a[92:93], v250 offset:3648
    ds_read_b64 a[94:95], v250 offset:3656
    ds_read_b128 a[124:127], v251 offset:64
    s_waitcnt lgkmcnt(15)
    v_mfma_f32_16x16x32_bf16 v[192:195], a[64:67], a[96:99], v[192:195]
    ds_read_b64 a[0:1], v250 offset:128
    v_mfma_f32_16x16x32_bf16 v[196:199], a[64:67], a[100:103], v[196:199]
    buffer_load_dwordx4 v241, s[64:67], s26 offen offset:1024 lds
    v_mfma_f32_16x16x32_bf16 v[196:199], a[68:71], a[96:99], v[196:199]
    ds_read_b64 a[2:3], v250 offset:136
    v_mfma_f32_16x16x32_bf16 v[200:203], a[68:71], a[100:103], v[200:203]
    ds_read_b128 a[32:35], v251 offset:3712
    v_mfma_f32_16x16x32_bf16 v[200:203], a[64:67], a[104:107], v[200:203]
    ds_read_b64 a[4:5], v250 offset:640
    v_mfma_f32_16x16x32_bf16 v[200:203], a[72:75], a[96:99], v[200:203]
    ds_read_b64 a[6:7], v250 offset:648
    v_mfma_f32_16x16x32_bf16 v[204:207], a[68:71], a[104:107], v[204:207]
    ds_read_b128 a[36:39], v251 offset:3200
    buffer_load_dwordx4 v242, s[64:67], s26 offen offset:2048 lds
    v_mfma_f32_16x16x32_bf16 v[204:207], a[72:75], a[100:103], v[204:207]
    ds_read_b64 a[8:9], v250 offset:1152
    v_mfma_f32_16x16x32_bf16 v[208:211], a[72:75], a[104:107], v[208:211]
    ds_read_b64 a[10:11], v250 offset:1160
    s_waitcnt lgkmcnt(15)
    v_mfma_f32_16x16x32_bf16 v[204:207], a[64:67], a[108:111], v[204:207]
    ds_read_b128 a[40:43], v251 offset:2688
    v_mfma_f32_16x16x32_bf16 v[204:207], a[76:79], a[96:99], v[204:207]
    ds_read_b64 a[12:13], v250 offset:1664
    v_mfma_f32_16x16x32_bf16 v[208:211], a[68:71], a[108:111], v[208:211]
    ds_read_b64 a[14:15], v250 offset:1672
    v_mfma_f32_16x16x32_bf16 v[208:211], a[76:79], a[100:103], v[208:211]
    buffer_load_dwordx4 v243, s[64:67], s26 offen offset:3072 lds
    v_mfma_f32_16x16x32_bf16 v[212:215], a[72:75], a[108:111], v[212:215]
    s_waitcnt vmcnt(12)
    ds_read_b64_tr_b16 v[160:161], v232 offset:0
    v_mfma_f32_16x16x32_bf16 v[212:215], a[76:79], a[104:107], v[212:215]
    ds_read_b64_tr_b16 v[162:163], v232 offset:512
    v_mfma_f32_16x16x32_bf16 v[216:219], a[76:79], a[108:111], v[216:219]
    ds_read_b64_tr_b16 v[164:165], v233 offset:0
    v_mfma_f32_16x16x32_bf16 v[208:211], a[64:67], a[112:115], v[208:211]
    ds_read_b64_tr_b16 v[166:167], v233 offset:512
    v_mfma_f32_16x16x32_bf16 v[208:211], a[80:83], a[96:99], v[208:211]
    ds_read_b64_tr_b16 v[168:169], v234 offset:0
    v_mfma_f32_16x16x32_bf16 v[212:215], a[68:71], a[112:115], v[212:215]
    ds_read_b64_tr_b16 v[170:171], v234 offset:512
    v_mfma_f32_16x16x32_bf16 v[212:215], a[80:83], a[100:103], v[212:215]
    ds_read_b64_tr_b16 v[172:173], v235 offset:0
    v_mfma_f32_16x16x32_bf16 v[216:219], a[72:75], a[112:115], v[216:219]
    ds_read_b64_tr_b16 v[174:175], v235 offset:512
    v_mfma_f32_16x16x32_bf16 v[216:219], a[80:83], a[104:107], v[216:219]
    s_lshl_b32 s26, s74, 6
    s_add_u32 m0, s22, 49152
    s_or_b32 s26, s26, s81
    buffer_load_dwordx4 v240, s[64:67], s26 offen offset:0 lds
    v_mfma_f32_16x16x32_bf16 v[220:223], a[76:79], a[112:115], v[220:223]
    ds_read_b128 a[44:47], v251 offset:2176
    v_mfma_f32_16x16x32_bf16 v[220:223], a[80:83], a[108:111], v[220:223]
    ds_read_b64 a[16:17], v250 offset:2176
    s_waitcnt lgkmcnt(15)
    v_mfma_f32_16x16x32_bf16 v[212:215], a[64:67], a[116:119], v[212:215]
    ds_read_b64 a[18:19], v250 offset:2184
    v_mfma_f32_16x16x32_bf16 v[212:215], a[84:87], a[96:99], v[212:215]
    ds_read_b128 a[48:51], v251 offset:1664
    v_mfma_f32_16x16x32_bf16 v[216:219], a[68:71], a[116:119], v[216:219]
    buffer_load_dwordx4 v241, s[64:67], s26 offen offset:1024 lds
    v_mfma_f32_16x16x32_bf16 v[216:219], a[84:87], a[100:103], v[216:219]
    ds_read_b64 a[20:21], v250 offset:2688
    v_mfma_f32_16x16x32_bf16 v[220:223], a[72:75], a[116:119], v[220:223]
    ds_read_b64 a[22:23], v250 offset:2696
    v_mfma_f32_16x16x32_bf16 v[220:223], a[84:87], a[104:107], v[220:223]
    ds_read_b128 a[52:55], v251 offset:1152
    v_mfma_f32_16x16x32_bf16 v[216:219], a[64:67], a[120:123], v[216:219]
    ds_read_b64 a[24:25], v250 offset:3200
    v_mfma_f32_16x16x32_bf16 v[216:219], a[88:91], a[96:99], v[216:219]
    ds_read_b64 a[26:27], v250 offset:3208
    buffer_load_dwordx4 v242, s[64:67], s26 offen offset:2048 lds
    v_mfma_f32_16x16x32_bf16 v[220:223], a[68:71], a[120:123], v[220:223]
    ds_read_b128 a[56:59], v251 offset:640
    v_mfma_f32_16x16x32_bf16 v[220:223], a[88:91], a[100:103], v[220:223]
    ds_read_b64 a[28:29], v250 offset:3712
    v_mfma_f32_16x16x32_bf16 v[220:223], a[64:67], a[124:127], v[220:223]
    ds_read_b64 a[30:31], v250 offset:3720
    buffer_load_dwordx4 v243, s[64:67], s26 offen offset:3072 lds
    v_mfma_f32_16x16x32_bf16 v[220:223], a[92:95], a[96:99], v[220:223]
    ds_read_b128 a[60:63], v251 offset:128
    v_mfma_f32_16x16x32_bf16 v[192:195], a[0:3], a[32:35], v[192:195]
    ds_read_b64 a[64:65], v250 offset:192
    v_mfma_f32_16x16x32_bf16 v[196:199], a[0:3], a[36:39], v[196:199]
    s_lshl_b32 s26, s75, 6
    s_add_u32 m0, s22, 65536
    s_or_b32 s26, s26, s81
    buffer_load_dwordx4 v240, s[64:67], s26 offen offset:0 lds
    v_mfma_f32_16x16x32_bf16 v[196:199], a[4:7], a[32:35], v[196:199]
    s_waitcnt vmcnt(13)
    ds_read_b64_tr_b16 v[176:177], v232 offset:16384
    v_mfma_f32_16x16x32_bf16 v[200:203], a[4:7], a[36:39], v[200:203]
    ds_read_b64_tr_b16 v[178:179], v232 offset:16896
    s_waitcnt lgkmcnt(15)
    v_mfma_f32_16x16x32_bf16 v[200:203], a[0:3], a[40:43], v[200:203]
    ds_read_b64_tr_b16 v[180:181], v233 offset:16384
    buffer_load_dwordx4 v241, s[64:67], s26 offen offset:1024 lds
    v_mfma_f32_16x16x32_bf16 v[200:203], a[8:11], a[32:35], v[200:203]
    ds_read_b64_tr_b16 v[182:183], v233 offset:16896
    v_mfma_f32_16x16x32_bf16 v[204:207], a[4:7], a[40:43], v[204:207]
    ds_read_b64_tr_b16 v[184:185], v234 offset:16384
    v_mfma_f32_16x16x32_bf16 v[204:207], a[8:11], a[36:39], v[204:207]
    ds_read_b64_tr_b16 v[186:187], v234 offset:16896
    buffer_load_dwordx4 v242, s[64:67], s26 offen offset:2048 lds
    v_mfma_f32_16x16x32_bf16 v[208:211], a[8:11], a[40:43], v[208:211]
    ds_read_b64_tr_b16 v[188:189], v235 offset:16384
    v_mfma_f32_16x16x32_bf16 v[204:207], a[0:3], a[44:47], v[204:207]
    ds_read_b64_tr_b16 v[190:191], v235 offset:16896
    v_mfma_f32_16x16x32_bf16 v[204:207], a[12:15], a[32:35], v[204:207]
    buffer_load_dwordx4 v243, s[64:67], s26 offen offset:3072 lds
    v_mfma_f32_16x16x32_bf16 v[208:211], a[4:7], a[44:47], v[208:211]
    ds_read_b64 a[66:67], v250 offset:200
    v_mfma_f32_16x16x32_bf16 v[208:211], a[12:15], a[36:39], v[208:211]
    ds_read_b128 a[96:99], v251 offset:3776
    v_mfma_f32_16x16x32_bf16 v[212:215], a[8:11], a[44:47], v[212:215]
    s_lshl_b32 s26, s76, 6
    s_add_u32 m0, s22, 81920
    s_or_b32 s26, s26, s81
    buffer_load_dwordx4 v240, s[64:67], s26 offen offset:0 lds
    v_mfma_f32_16x16x32_bf16 v[212:215], a[12:15], a[40:43], v[212:215]
    ds_read_b64 a[68:69], v250 offset:704
    v_mfma_f32_16x16x32_bf16 v[216:219], a[12:15], a[44:47], v[216:219]
    ds_read_b64 a[70:71], v250 offset:712
    s_waitcnt lgkmcnt(15)
    v_mfma_f32_16x16x32_bf16 v[208:211], a[0:3], a[48:51], v[208:211]
    buffer_load_dwordx4 v241, s[64:67], s26 offen offset:1024 lds
    v_mfma_f32_16x16x32_bf16 v[208:211], a[16:19], a[32:35], v[208:211]
    ds_read_b128 a[100:103], v251 offset:3264
    v_mfma_f32_16x16x32_bf16 v[212:215], a[4:7], a[48:51], v[212:215]
    ds_read_b64 a[72:73], v250 offset:1216
    v_mfma_f32_16x16x32_bf16 v[212:215], a[16:19], a[36:39], v[212:215]
    buffer_load_dwordx4 v242, s[64:67], s26 offen offset:2048 lds
    v_mfma_f32_16x16x32_bf16 v[216:219], a[8:11], a[48:51], v[216:219]
    ds_read_b64 a[74:75], v250 offset:1224
    v_mfma_f32_16x16x32_bf16 v[216:219], a[16:19], a[40:43], v[216:219]
    ds_read_b128 a[104:107], v251 offset:2752
    v_mfma_f32_16x16x32_bf16 v[220:223], a[12:15], a[48:51], v[220:223]
    ds_read_b64 a[76:77], v250 offset:1728
    buffer_load_dwordx4 v243, s[64:67], s26 offen offset:3072 lds
    v_mfma_f32_16x16x32_bf16 v[220:223], a[16:19], a[44:47], v[220:223]
    ds_read_b64 a[78:79], v250 offset:1736
    v_mfma_f32_16x16x32_bf16 v[212:215], a[0:3], a[52:55], v[212:215]
    ds_read_b128 a[108:111], v251 offset:2240
    v_mfma_f32_16x16x32_bf16 v[212:215], a[20:23], a[32:35], v[212:215]
    v_min_u32 v14, 6, v1
    v_lshlrev_b32 v14, 3, v14
    s_lshl_b32 s93, s8, 9
    s_lshl_b32 s92, s3, 6
    s_add_u32 s93, s93, s92
    s_add_u32 s93, s93, 12656640
    buffer_load_dwordx2 v[248:249], v14, s[52:55], s93 offen sc1
    v_mfma_f32_16x16x32_bf16 v[216:219], a[4:7], a[52:55], v[216:219]
    ds_read_b64 a[80:81], v250 offset:2240
    v_mfma_f32_16x16x32_bf16 v[216:219], a[20:23], a[36:39], v[216:219]
    ds_read_b64 a[82:83], v250 offset:2248
    v_mfma_f32_16x16x32_bf16 v[220:223], a[8:11], a[52:55], v[220:223]
    ds_read_b128 a[112:115], v251 offset:1728
    v_mfma_f32_16x16x32_bf16 v[220:223], a[20:23], a[40:43], v[220:223]
    ds_read_b64 a[84:85], v250 offset:2752
    v_mfma_f32_16x16x32_bf16 v[216:219], a[0:3], a[56:59], v[216:219]
    s_lshl_b32 s26, s77, 6
    s_add_u32 m0, s22, 0
    s_or_b32 s26, s26, s81
    buffer_load_dwordx4 v240, s[64:67], s26 offen offset:0 lds
    v_mfma_f32_16x16x32_bf16 v[216:219], a[24:27], a[32:35], v[216:219]
    ds_read_b64 a[86:87], v250 offset:2760
    v_mfma_f32_16x16x32_bf16 v[220:223], a[4:7], a[56:59], v[220:223]
    ds_read_b128 a[116:119], v251 offset:1216
    v_mfma_f32_16x16x32_bf16 v[220:223], a[24:27], a[36:39], v[220:223]
    ds_read_b64 a[88:89], v250 offset:3264
    buffer_load_dwordx4 v241, s[64:67], s26 offen offset:1024 lds
    s_waitcnt lgkmcnt(15)
    v_mfma_f32_16x16x32_bf16 v[220:223], a[0:3], a[60:63], v[220:223]
    ds_read_b64 a[90:91], v250 offset:3272
    v_mfma_f32_16x16x32_bf16 v[220:223], a[28:31], a[32:35], v[220:223]
    ds_read_b128 a[120:123], v251 offset:704
    ds_read_b64 a[92:93], v250 offset:3776
    ds_read_b64 a[94:95], v250 offset:3784
    ds_read_b128 a[124:127], v251 offset:192
    v_mfma_f32_16x16x32_bf16 v[192:195], a[64:67], a[96:99], v[192:195]
    buffer_load_dwordx4 v242, s[64:67], s26 offen offset:2048 lds
    s_waitcnt lgkmcnt(15)
    v_mfma_f32_16x16x32_bf16 v[196:199], a[64:67], a[100:103], v[196:199]
    v_mfma_f32_16x16x32_bf16 v[196:199], a[68:71], a[96:99], v[196:199]
    buffer_load_dwordx4 v243, s[64:67], s26 offen offset:3072 lds
    v_mfma_f32_16x16x32_bf16 v[200:203], a[68:71], a[100:103], v[200:203]
    v_mfma_f32_16x16x32_bf16 v[200:203], a[64:67], a[104:107], v[200:203]
    v_mfma_f32_16x16x32_bf16 v[200:203], a[72:75], a[96:99], v[200:203]
    s_lshl_b32 s26, s78, 6
    s_add_u32 m0, s22, 16384
    s_or_b32 s26, s26, s81
    buffer_load_dwordx4 v240, s[64:67], s26 offen offset:0 lds
    v_mfma_f32_16x16x32_bf16 v[204:207], a[68:71], a[104:107], v[204:207]
    v_mfma_f32_16x16x32_bf16 v[204:207], a[72:75], a[100:103], v[204:207]
    v_mfma_f32_16x16x32_bf16 v[208:211], a[72:75], a[104:107], v[208:211]
    s_waitcnt lgkmcnt(12)
    v_mfma_f32_16x16x32_bf16 v[204:207], a[64:67], a[108:111], v[204:207]
    buffer_load_dwordx4 v241, s[64:67], s26 offen offset:1024 lds
    v_mfma_f32_16x16x32_bf16 v[204:207], a[76:79], a[96:99], v[204:207]
    v_mfma_f32_16x16x32_bf16 v[208:211], a[68:71], a[108:111], v[208:211]
    v_mfma_f32_16x16x32_bf16 v[208:211], a[76:79], a[100:103], v[208:211]
    buffer_load_dwordx4 v242, s[64:67], s26 offen offset:2048 lds
    v_mfma_f32_16x16x32_bf16 v[212:215], a[72:75], a[108:111], v[212:215]
    v_mfma_f32_16x16x32_bf16 v[212:215], a[76:79], a[104:107], v[212:215]
    v_mfma_f32_16x16x32_bf16 v[216:219], a[76:79], a[108:111], v[216:219]
    buffer_load_dwordx4 v243, s[64:67], s26 offen offset:3072 lds
    s_waitcnt lgkmcnt(9)
    v_mfma_f32_16x16x32_bf16 v[208:211], a[64:67], a[112:115], v[208:211]
    v_mfma_f32_16x16x32_bf16 v[208:211], a[80:83], a[96:99], v[208:211]
    v_mfma_f32_16x16x32_bf16 v[212:215], a[68:71], a[112:115], v[212:215]
    v_mfma_f32_16x16x32_bf16 v[212:215], a[80:83], a[100:103], v[212:215]
    v_mfma_f32_16x16x32_bf16 v[216:219], a[72:75], a[112:115], v[216:219]
    v_mfma_f32_16x16x32_bf16 v[216:219], a[80:83], a[104:107], v[216:219]
    v_mfma_f32_16x16x32_bf16 v[220:223], a[76:79], a[112:115], v[220:223]
    v_mfma_f32_16x16x32_bf16 v[220:223], a[80:83], a[108:111], v[220:223]
    s_waitcnt lgkmcnt(6)
    v_mfma_f32_16x16x32_bf16 v[212:215], a[64:67], a[116:119], v[212:215]
    v_mfma_f32_16x16x32_bf16 v[212:215], a[84:87], a[96:99], v[212:215]
    v_mfma_f32_16x16x32_bf16 v[216:219], a[68:71], a[116:119], v[216:219]
    s_waitcnt vmcnt(8)
    v_cmp_ne_u64 vcc, s[88:89], v[248:249]
    s_cbranch_vccnz L_pl_37
L_pd_38:
    v_mfma_f32_16x16x32_bf16 v[216:219], a[84:87], a[100:103], v[216:219]
    s_add_u32 s72, s72, s82
    buffer_load_dwordx4 a[128:131], v244, s[52:55], s72 offen sc1
    v_mfma_f32_16x16x32_bf16 v[220:223], a[72:75], a[116:119], v[220:223]
    v_mfma_f32_16x16x32_bf16 v[220:223], a[84:87], a[104:107], v[220:223]
    buffer_load_dwordx4 a[132:135], v245, s[52:55], s72 offen sc1
    s_waitcnt lgkmcnt(3)
    v_mfma_f32_16x16x32_bf16 v[216:219], a[64:67], a[120:123], v[216:219]
    v_mfma_f32_16x16x32_bf16 v[216:219], a[88:91], a[96:99], v[216:219]
    buffer_load_dwordx4 a[136:139], v246, s[52:55], s72 offen sc1
    v_mfma_f32_16x16x32_bf16 v[220:223], a[68:71], a[120:123], v[220:223]
    v_mfma_f32_16x16x32_bf16 v[220:223], a[88:91], a[100:103], v[220:223]
    buffer_load_dwordx4 a[140:143], v247, s[52:55], s72 offen sc1
    s_waitcnt lgkmcnt(0)
    v_mfma_f32_16x16x32_bf16 v[220:223], a[64:67], a[124:127], v[220:223]
    v_mfma_f32_16x16x32_bf16 v[220:223], a[92:95], a[96:99], v[220:223]
    s_add_u32 s73, s73, s82
    buffer_load_dwordx4 a[144:147], v244, s[52:55], s73 offen sc1
    s_nop 7
    s_add_u32 s24, s22, 130560
    v_add_u32 v8, s24, v11
    s_xor_b32 s25, s22, 4096
    s_add_u32 s25, s25, 130560
    v_add_u32 v9, s25, v11
    v_lshlrev_b32 v5, 5, v3
    v_lshl_add_u32 v5, v4, 3, v5
    s_sub_u32 s24, s20, s36
    s_add_u32 s24, s24, 2552
    v_sub_u32 v6, s24, v5
    ds_read_b64 v[224:225], v6 offset:1536
    ds_read_b64 v[226:227], v6 offset:1024
    ds_read_b64 v[228:229], v6 offset:512
    ds_read_b64 v[230:231], v6 offset:0
    s_barrier
    s_cmp_lg_u32 s33, 0
    s_cbranch_scc1 L_e1_39
    ds_write_b128 v8, v[208:211] offset:0
    ds_write_b128 v8, v[212:215] offset:1024
    ds_write_b128 v8, v[216:219] offset:2048
    ds_write_b128 v8, v[220:223] offset:3072
L_ej_40:
    buffer_load_dwordx4 a[148:151], v245, s[52:55], s73 offen sc1
    buffer_load_dwordx4 a[152:155], v246, s[52:55], s73 offen sc1
    s_lshl_b32 s24, s32, 4
    s_lshr_b32 s24, s39, s24
    s_lshl_b32 s19, s24, 16
    v_and_b32 v8, 1, v4
    buffer_load_dwordx4 a[156:159], v247, s[52:55], s73 offen sc1
    s_add_u32 s74, s74, s82
    buffer_load_dwordx4 a[160:163], v244, s[52:55], s74 offen sc1
    v_lshlrev_b32 v8, 9, v8
    v_lshrrev_b32 v7, 1, v4
    v_lshl_add_u32 v8, v7, 4, v8
    buffer_load_dwordx4 a[164:167], v245, s[52:55], s74 offen sc1
    buffer_load_dwordx4 a[168:171], v246, s[52:55], s74 offen sc1
    v_lshl_add_u32 v8, v3, 5, v8
    s_add_u32 s21, s37, 10485760
    s_waitcnt lgkmcnt(4)
    v_and_b32 v32, 0xffff0000, v225
    v_lshlrev_b32 v33, 16, v225
    v_and_b32 v34, 0xffff0000, v224
    v_lshlrev_b32 v35, 16, v224
    v_and_b32 v36, 0xffff0000, v227
    v_lshlrev_b32 v37, 16, v227
    v_and_b32 v38, 0xffff0000, v226
    v_lshlrev_b32 v39, 16, v226
    v_and_b32 v40, 0xffff0000, v229
    v_lshlrev_b32 v41, 16, v229
    v_and_b32 v42, 0xffff0000, v228
    v_lshlrev_b32 v43, 16, v228
    v_and_b32 v44, 0xffff0000, v231
    v_lshlrev_b32 v45, 16, v231
    v_and_b32 v46, 0xffff0000, v230
    v_lshlrev_b32 v47, 16, v230
    s_waitcnt lgkmcnt(0)
    s_barrier
    ds_read_b128 v[16:19], v9 offset:0
    ds_read_b128 v[20:23], v9 offset:1024
    ds_read_b128 v[24:27], v9 offset:2048
    ds_read_b128 v[28:31], v9 offset:3072
    s_mov_b32 s24, s19
    s_cmp_lg_u32 s33, 0
    s_cbranch_scc1 L_e1_41
    v_pk_fma_f32 v[48:49], v[32:33], s[24:25], v[192:193] op_sel_hi:[1,0,1]
    v_pk_fma_f32 v[50:51], v[34:35], s[24:25], v[194:195] op_sel_hi:[1,0,1]
    v_pk_fma_f32 v[52:53], v[36:37], s[24:25], v[196:197] op_sel_hi:[1,0,1]
    v_pk_fma_f32 v[54:55], v[38:39], s[24:25], v[198:199] op_sel_hi:[1,0,1]
    v_pk_fma_f32 v[56:57], v[40:41], s[24:25], v[200:201] op_sel_hi:[1,0,1]
    v_pk_fma_f32 v[58:59], v[42:43], s[24:25], v[202:203] op_sel_hi:[1,0,1]
    v_pk_fma_f32 v[60:61], v[44:45], s[24:25], v[204:205] op_sel_hi:[1,0,1]
    v_pk_fma_f32 v[62:63], v[46:47], s[24:25], v[206:207] op_sel_hi:[1,0,1]
L_ej_42:
    s_waitcnt lgkmcnt(3)
    buffer_load_dwordx4 a[172:175], v247, s[52:55], s74 offen sc1
    s_add_u32 s75, s75, s82
    buffer_load_dwordx4 a[176:179], v244, s[52:55], s75 offen sc1
    v_pk_add_f32 v[48:49], v[48:49], v[16:17]
    v_pk_add_f32 v[50:51], v[50:51], v[18:19]
    v_cvt_pk_bf16_f32 v192, v48, v49
    v_cvt_pk_bf16_f32 v193, v50, v51
    s_waitcnt lgkmcnt(2)
    v_pk_add_f32 v[52:53], v[52:53], v[20:21]
    v_pk_add_f32 v[54:55], v[54:55], v[22:23]
    v_cvt_pk_bf16_f32 v194, v52, v53
    v_cvt_pk_bf16_f32 v195, v54, v55
    s_nop 1
    v_permlane16_swap_b32 v192, v194
    v_permlane16_swap_b32 v193, v195
    buffer_store_dwordx4 v[192:195], v8, s[52:55], s21 offen offset:0 sc1
    s_waitcnt lgkmcnt(1)
    v_pk_add_f32 v[56:57], v[56:57], v[24:25]
    v_pk_add_f32 v[58:59], v[58:59], v[26:27]
    v_cvt_pk_bf16_f32 v200, v56, v57
    v_cvt_pk_bf16_f32 v201, v58, v59
    s_waitcnt lgkmcnt(0)
    v_pk_add_f32 v[60:61], v[60:61], v[28:29]
    v_pk_add_f32 v[62:63], v[62:63], v[30:31]
    v_cvt_pk_bf16_f32 v202, v60, v61
    v_cvt_pk_bf16_f32 v203, v62, v63
    s_nop 1
    v_permlane16_swap_b32 v200, v202
    v_permlane16_swap_b32 v201, v203
    buffer_store_dwordx4 v[200:203], v8, s[52:55], s21 offen offset:1024 sc1
    s_waitcnt vmcnt(11)
    v_mfma_f32_16x16x32_bf16 v[16:19], v[80:83], a[128:131], 0
    ds_read_b64_tr_b16 a[240:241], v236 offset:32768
    v_mfma_f32_16x16x32_bf16 v[20:23], v[80:83], a[132:135], 0
    ds_read_b64_tr_b16 a[242:243], v236 offset:33280
    v_mfma_f32_16x16x32_bf16 v[24:27], v[80:83], a[136:139], 0
    ds_read_b64_tr_b16 a[244:245], v237 offset:32768
    buffer_load_dwordx4 a[180:183], v245, s[52:55], s75 offen sc1
    v_mfma_f32_16x16x32_bf16 v[28:31], v[80:83], a[140:143], 0
    ds_read_b64_tr_b16 a[246:247], v237 offset:33280
    v_mfma_f32_16x16x32_bf16 v[32:35], v[84:87], a[128:131], 0
    ds_read_b64_tr_b16 a[248:249], v238 offset:32768
    v_mfma_f32_16x16x32_bf16 v[36:39], v[84:87], a[132:135], 0
    ds_read_b64_tr_b16 a[250:251], v238 offset:33280
    v_mfma_f32_16x16x32_bf16 v[40:43], v[84:87], a[136:139], 0
    ds_read_b64_tr_b16 a[252:253], v239 offset:32768
    v_mfma_f32_16x16x32_bf16 v[44:47], v[84:87], a[140:143], 0
    ds_read_b64_tr_b16 a[254:255], v239 offset:33280
    v_mfma_f32_16x16x32_bf16 v[48:51], v[88:91], a[128:131], 0
    v_mfma_f32_16x16x32_bf16 v[52:55], v[88:91], a[132:135], 0
    v_mfma_f32_16x16x32_bf16 v[56:59], v[88:91], a[136:139], 0
    v_mfma_f32_16x16x32_bf16 v[60:63], v[88:91], a[140:143], 0
    buffer_load_dwordx4 a[184:187], v246, s[52:55], s75 offen sc1
    v_mfma_f32_16x16x32_bf16 v[64:67], v[92:95], a[128:131], 0
    v_mfma_f32_16x16x32_bf16 v[68:71], v[92:95], a[132:135], 0
    v_mfma_f32_16x16x32_bf16 v[72:75], v[92:95], a[136:139], 0
    buffer_load_dwordx4 a[188:191], v247, s[52:55], s75 offen sc1
    v_mfma_f32_16x16x32_bf16 v[76:79], v[92:95], a[140:143], 0
    v_min_u32 v14, 6, v1
    v_lshlrev_b32 v14, 3, v14
    s_lshl_b32 s93, s8, 9
    s_lshl_b32 s92, s3, 6
    s_add_u32 s93, s93, s92
    s_add_u32 s93, s93, 12656896
    buffer_load_dwordx2 v[248:249], v14, s[52:55], s93 offen sc1
    s_waitcnt vmcnt(11)
    v_mfma_f32_16x16x32_bf16 v[16:19], v[96:99], a[144:147], v[16:19]
    ds_read_b64_tr_b16 a[224:225], v232 offset:32768
    v_mfma_f32_16x16x32_bf16 v[20:23], v[96:99], a[148:151], v[20:23]
    ds_read_b64_tr_b16 a[226:227], v232 offset:33280
    v_mfma_f32_16x16x32_bf16 v[24:27], v[96:99], a[152:155], v[24:27]
    ds_read_b64_tr_b16 a[228:229], v233 offset:32768
    s_add_u32 s76, s76, s82
    buffer_load_dwordx4 a[192:195], v244, s[52:55], s76 offen sc1
    v_mfma_f32_16x16x32_bf16 v[28:31], v[96:99], a[156:159], v[28:31]
    ds_read_b64_tr_b16 a[230:231], v233 offset:33280
    v_mfma_f32_16x16x32_bf16 v[32:35], v[100:103], a[144:147], v[32:35]
    ds_read_b64_tr_b16 a[232:233], v234 offset:32768
    v_mfma_f32_16x16x32_bf16 v[36:39], v[100:103], a[148:151], v[36:39]
    buffer_load_dwordx4 a[196:199], v245, s[52:55], s76 offen sc1
    v_mfma_f32_16x16x32_bf16 v[40:43], v[100:103], a[152:155], v[40:43]
    ds_read_b64_tr_b16 a[234:235], v234 offset:33280
    v_mfma_f32_16x16x32_bf16 v[44:47], v[100:103], a[156:159], v[44:47]
    ds_read_b64_tr_b16 a[236:237], v235 offset:32768
    v_mfma_f32_16x16x32_bf16 v[48:51], v[104:107], a[144:147], v[48:51]
    ds_read_b64_tr_b16 a[238:239], v235 offset:33280
    buffer_load_dwordx4 a[200:203], v246, s[52:55], s76 offen sc1
    v_mfma_f32_16x16x32_bf16 v[52:55], v[104:107], a[148:151], v[52:55]
    v_mfma_f32_16x16x32_bf16 v[56:59], v[104:107], a[152:155], v[56:59]
    v_mfma_f32_16x16x32_bf16 v[60:63], v[104:107], a[156:159], v[60:63]
    buffer_load_dwordx4 a[204:207], v247, s[52:55], s76 offen sc1
    v_mfma_f32_16x16x32_bf16 v[64:67], v[108:111], a[144:147], v[64:67]
    v_mfma_f32_16x16x32_bf16 v[68:71], v[108:111], a[148:151], v[68:71]
    v_mfma_f32_16x16x32_bf16 v[72:75], v[108:111], a[152:155], v[72:75]
    v_mfma_f32_16x16x32_bf16 v[76:79], v[108:111], a[156:159], v[76:79]
    s_add_u32 s77, s77, s82
    buffer_load_dwordx4 a[208:211], v244, s[52:55], s77 offen sc1
    s_waitcnt vmcnt(12)
    v_mfma_f32_16x16x32_bf16 v[16:19], v[112:115], a[160:163], v[16:19]
    ds_read_b64_tr_b16 a[128:129], v232 offset:49152
    v_mfma_f32_16x16x32_bf16 v[20:23], v[112:115], a[164:167], v[20:23]
    ds_read_b64_tr_b16 a[130:131], v232 offset:49664
    v_mfma_f32_16x16x32_bf16 v[24:27], v[112:115], a[168:171], v[24:27]
    ds_read_b64_tr_b16 a[132:133], v233 offset:49152
    v_mfma_f32_16x16x32_bf16 v[28:31], v[112:115], a[172:175], v[28:31]
    ds_read_b64_tr_b16 a[134:135], v233 offset:49664
    v_mfma_f32_16x16x32_bf16 v[32:35], v[116:119], a[160:163], v[32:35]
    ds_read_b64_tr_b16 a[136:137], v234 offset:49152
    v_mfma_f32_16x16x32_bf16 v[36:39], v[116:119], a[164:167], v[36:39]
    ds_read_b64_tr_b16 a[138:139], v234 offset:49664
    v_mfma_f32_16x16x32_bf16 v[40:43], v[116:119], a[168:171], v[40:43]
    ds_read_b64_tr_b16 a[140:141], v235 offset:49152
    v_mfma_f32_16x16x32_bf16 v[44:47], v[116:119], a[172:175], v[44:47]
    ds_read_b64_tr_b16 a[142:143], v235 offset:49664
    v_mfma_f32_16x16x32_bf16 v[48:51], v[120:123], a[160:163], v[48:51]
    v_mfma_f32_16x16x32_bf16 v[52:55], v[120:123], a[164:167], v[52:55]
    v_mfma_f32_16x16x32_bf16 v[56:59], v[120:123], a[168:171], v[56:59]
    v_mfma_f32_16x16x32_bf16 v[60:63], v[120:123], a[172:175], v[60:63]
    v_mfma_f32_16x16x32_bf16 v[64:67], v[124:127], a[160:163], v[64:67]
    v_mfma_f32_16x16x32_bf16 v[68:71], v[124:127], a[164:167], v[68:71]
    v_mfma_f32_16x16x32_bf16 v[72:75], v[124:127], a[168:171], v[72:75]
    v_mfma_f32_16x16x32_bf16 v[76:79], v[124:127], a[172:175], v[76:79]
    buffer_load_dwordx4 a[212:215], v245, s[52:55], s77 offen sc1
    buffer_load_dwordx4 a[216:219], v246, s[52:55], s77 offen sc1
    buffer_load_dwordx4 a[220:223], v247, s[52:55], s77 offen sc1
    s_add_u32 s78, s78, s82
    buffer_load_dwordx4 a[0:3], v244, s[52:55], s78 offen sc1
    s_waitcnt vmcnt(10)
    v_mfma_f32_16x16x32_bf16 v[16:19], v[128:131], a[176:179], v[16:19]
    s_lshl_b32 s92, s4, 1
    s_add_u32 s92, s92, s33
    s_lshl_b32 s92, s92, 6
    s_lshl_b32 s24, s5, 1
    s_add_u32 s92, s92, s24
    s_add_u32 s92, s92, s32
    s_lshl_b32 s92, s92, 7
    s_add_u32 s92, s92, 12681216
    s_mov_b64 exec, 1
    buffer_store_dwordx2 v[12:13], v10, s[52:55], s92 offen sc1
    s_mov_b64 exec, -1
    v_mfma_f32_16x16x32_bf16 v[20:23], v[128:131], a[180:183], v[20:23]
    ds_read_b64_tr_b16 a[144:145], v236 offset:0
    v_mfma_f32_16x16x32_bf16 v[24:27], v[128:131], a[184:187], v[24:27]
    ds_read_b64_tr_b16 a[146:147], v236 offset:512
    buffer_load_dwordx4 a[4:7], v245, s[52:55], s78 offen sc1
    v_mfma_f32_16x16x32_bf16 v[28:31], v[128:131], a[188:191], v[28:31]
    ds_read_b64_tr_b16 a[148:149], v237 offset:0
    v_mfma_f32_16x16x32_bf16 v[32:35], v[132:135], a[176:179], v[32:35]
    ds_read_b64_tr_b16 a[150:151], v237 offset:512
    v_mfma_f32_16x16x32_bf16 v[36:39], v[132:135], a[180:183], v[36:39]
    buffer_load_dwordx4 a[8:11], v246, s[52:55], s78 offen sc1
    v_mfma_f32_16x16x32_bf16 v[40:43], v[132:135], a[184:187], v[40:43]
    ds_read_b64_tr_b16 a[152:153], v238 offset:0
    v_mfma_f32_16x16x32_bf16 v[44:47], v[132:135], a[188:191], v[44:47]
    ds_read_b64_tr_b16 a[154:155], v238 offset:512
    v_mfma_f32_16x16x32_bf16 v[48:51], v[136:139], a[176:179], v[48:51]
    ds_read_b64_tr_b16 a[156:157], v239 offset:0
    buffer_load_dwordx4 a[12:15], v247, s[52:55], s78 offen sc1
    v_mfma_f32_16x16x32_bf16 v[52:55], v[136:139], a[180:183], v[52:55]
    s_waitcnt vmcnt(12)
    v_cmp_ne_u64 vcc, s[88:89], v[248:249]
    s_cbranch_vccnz L_pl_43
L_pd_44:
    v_mfma_f32_16x16x32_bf16 v[56:59], v[136:139], a[184:187], v[56:59]
    ds_read_b64_tr_b16 a[158:159], v239 offset:512
    v_mfma_f32_16x16x32_bf16 v[60:63], v[136:139], a[188:191], v[60:63]
    s_add_u32 s72, s72, s83
    buffer_load_dwordx4 a[16:19], v244, s[52:55], s72 offen sc1
    v_mfma_f32_16x16x32_bf16 v[64:67], v[140:143], a[176:179], v[64:67]
    v_mfma_f32_16x16x32_bf16 v[68:71], v[140:143], a[180:183], v[68:71]
    v_mfma_f32_16x16x32_bf16 v[72:75], v[140:143], a[184:187], v[72:75]
    v_mfma_f32_16x16x32_bf16 v[76:79], v[140:143], a[188:191], v[76:79]
    buffer_load_dwordx4 a[20:23], v245, s[52:55], s72 offen sc1
    s_waitcnt vmcnt(10)
    v_mfma_f32_16x16x32_bf16 v[16:19], v[144:147], a[192:195], v[16:19]
    s_barrier
    ds_read_b64_tr_b16 a[160:161], v236 offset:16384
    s_add_u32 s26, s3, 1
    v_mfma_f32_16x16x32_bf16 v[20:23], v[144:147], a[196:199], v[20:23]
    s_and_b32 s26, s26, 3
    ds_read_b64_tr_b16 a[162:163], v236 offset:16896
    buffer_load_dwordx4 a[24:27], v246, s[52:55], s72 offen sc1
    v_mfma_f32_16x16x32_bf16 v[24:27], v[144:147], a[200:203], v[24:27]
    s_mul_i32 s26, s26, 12288
    ds_read_b64_tr_b16 a[164:165], v237 offset:16384
    s_add_u32 s26, s26, 114688
    v_mfma_f32_16x16x32_bf16 v[28:31], v[144:147], a[204:207], v[28:31]
    ds_read_b64_tr_b16 a[166:167], v237 offset:16896
    v_add_u32 v192, s26, v11
    v_mfma_f32_16x16x32_bf16 v[32:35], v[148:151], a[192:195], v[32:35]
    s_add_u32 s26, s3, 2
    ds_read_b64_tr_b16 a[168:169], v238 offset:16384
    buffer_load_dwordx4 a[28:31], v247, s[52:55], s72 offen sc1
    v_mfma_f32_16x16x32_bf16 v[36:39], v[148:151], a[196:199], v[36:39]
    s_and_b32 s26, s26, 3
    ds_read_b64_tr_b16 a[170:171], v238 offset:16896
    s_mul_i32 s26, s26, 12288
    v_mfma_f32_16x16x32_bf16 v[40:43], v[148:151], a[200:203], v[40:43]
    s_add_u32 s26, s26, 118784
    ds_read_b64_tr_b16 a[172:173], v239 offset:16384
    v_add_u32 v193, s26, v11
    v_mfma_f32_16x16x32_bf16 v[44:47], v[148:151], a[204:207], v[44:47]
    s_add_u32 s26, s3, 3
    s_add_u32 s73, s73, s83
    buffer_load_dwordx4 a[36:39], v245, s[52:55], s73 offen sc1
    v_mfma_f32_16x16x32_bf16 v[48:51], v[152:155], a[192:195], v[48:51]
    s_and_b32 s26, s26, 3
    ds_read_b64_tr_b16 a[174:175], v239 offset:16896
    s_mul_i32 s26, s26, 12288
    v_mfma_f32_16x16x32_bf16 v[52:55], v[152:155], a[196:199], v[52:55]
    s_add_u32 s26, s26, 122880
    v_add_u32 v194, s26, v11
    v_lshlrev_b32 v195, 7, v3
    v_mfma_f32_16x16x32_bf16 v[56:59], v[152:155], a[200:203], v[56:59]
    v_lshl_add_u32 v195, v4, 3, v195
    s_mul_i32 s26, s3, 12288
    v_mfma_f32_16x16x32_bf16 v[60:63], v[152:155], a[204:207], v[60:63]
    s_add_u32 s26, s26, 122880
    s_add_u32 s74, s74, s83
    buffer_load_dwordx4 a[52:55], v245, s[52:55], s74 offen sc1
    v_mfma_f32_16x16x32_bf16 v[64:67], v[156:159], a[192:195], v[64:67]
    v_add_u32 v195, s26, v195
    v_lshrrev_b32 v196, 2, v1
    v_mfma_f32_16x16x32_bf16 v[68:71], v[156:159], a[196:199], v[68:71]
    v_lshlrev_b32 v196, 7, v196
    v_and_b32 v199, 3, v1
    v_mfma_f32_16x16x32_bf16 v[72:75], v[156:159], a[200:203], v[72:75]
    s_add_u32 s75, s75, s83
    buffer_load_dwordx4 a[68:71], v245, s[52:55], s75 offen sc1
    v_lshl_add_u32 v196, v199, 3, v196
    v_mfma_f32_16x16x32_bf16 v[76:79], v[156:159], a[204:207], v[76:79]
    s_lshl_b32 s26, s3, 5
    s_add_u32 s26, s26, 100352
    v_add_u32 v196, s26, v196
    s_waitcnt vmcnt(11)
    v_mfma_f32_16x16x32_bf16 v[16:19], v[160:163], a[208:211], v[16:19]
    s_mul_i32 s26, s3, 12288
    ds_read_b64_tr_b16 a[176:177], v232 offset:0
    s_add_u32 s26, s26, 114688
    v_mfma_f32_16x16x32_bf16 v[20:23], v[160:163], a[212:215], v[20:23]
    ds_read_b64_tr_b16 a[178:179], v232 offset:512
    v_add_u32 v197, s26, v11
    v_mfma_f32_16x16x32_bf16 v[24:27], v[160:163], a[216:219], v[24:27]
    ds_read_b64_tr_b16 a[180:181], v233 offset:0
    v_and_b32 v199, 1, v4
    v_mfma_f32_16x16x32_bf16 v[28:31], v[160:163], a[220:223], v[28:31]
    ds_read_b64_tr_b16 a[182:183], v233 offset:512
    v_lshrrev_b32 v198, 1, v4
    v_mfma_f32_16x16x32_bf16 v[32:35], v[164:167], a[208:211], v[32:35]
    ds_read_b64_tr_b16 a[184:185], v234 offset:0
    s_add_u32 s76, s76, s83
    buffer_load_dwordx4 a[84:87], v245, s[52:55], s76 offen sc1
    v_mfma_f32_16x16x32_bf16 v[36:39], v[164:167], a[212:215], v[36:39]
    ds_read_b64_tr_b16 a[186:187], v234 offset:512
    v_lshlrev_b32 v198, 4, v198
    v_mfma_f32_16x16x32_bf16 v[40:43], v[164:167], a[216:219], v[40:43]
    ds_read_b64_tr_b16 a[188:189], v235 offset:0
    v_lshl_add_u32 v198, v199, 5, v198
    v_mfma_f32_16x16x32_bf16 v[44:47], v[164:167], a[220:223], v[44:47]
    ds_read_b64_tr_b16 a[190:191], v235 offset:512
    s_add_u32 s77, s77, s83
    buffer_load_dwordx4 a[100:103], v245, s[52:55], s77 offen sc1
    v_mfma_f32_16x16x32_bf16 v[48:51], v[168:171], a[208:211], v[48:51]
    v_lshrrev_b32 v5, 3, v1
    v_and_b32 v6, 7, v1
    v_lshlrev_b32 v7, 12, v5
    v_lshl_add_u32 v7, v6, 4, v7
    v_lshlrev_b32 v5, 10, v5
    v_lshl_add_u32 v5, v6, 4, v5
    v_lshlrev_b32 v6, 3, v3
    v_mfma_f32_16x16x32_bf16 v[52:55], v[168:171], a[212:215], v[52:55]
    s_lshl_b32 s24, s9, 6
    s_add_u32 s78, s78, s83
    buffer_load_dwordx4 a[116:119], v245, s[52:55], s78 offen sc1
    v_mfma_f32_16x16x32_bf16 v[56:59], v[168:171], a[216:219], v[56:59]
    s_lshl_b32 s25, s3, 4
    s_add_u32 s24, s24, s25
    s_lshl_b32 s24, s24, 12
    v_mfma_f32_16x16x32_bf16 v[60:63], v[168:171], a[220:223], v[60:63]
    s_lshl_b32 s31, s8, 7
    s_add_u32 s24, s24, s31
    s_add_u32 s19, s24, 10485760
    v_mfma_f32_16x16x32_bf16 v[64:67], v[172:175], a[208:211], v[64:67]
    s_add_u32 s21, s19, 31744
    s_lshl_b32 s31, s8, 6
    buffer_load_dwordx4 a[40:43], v246, s[52:55], s73 offen sc1
    v_mfma_f32_16x16x32_bf16 v[68:71], v[172:175], a[212:215], v[68:71]
    s_add_u32 s31, s31, s25
    s_lshl_b32 s38, s31, 3
    s_add_u32 s38, s38, 12582912
    v_mfma_f32_16x16x32_bf16 v[72:75], v[172:175], a[216:219], v[72:75]
    s_lshl_b32 s24, s31, 10
    s_lshl_b32 s25, s9, 7
    s_add_u32 s31, s24, s25
    v_mfma_f32_16x16x32_bf16 v[76:79], v[172:175], a[220:223], v[76:79]
    s_add_u32 s34, s31, 7168
    v_lshl_add_u32 v198, v3, 10, v198
    s_lshl_b32 s27, s5, 2
    s_waitcnt vmcnt(11)
    v_mfma_f32_16x16x32_bf16 v[16:19], v[176:179], a[0:3], v[16:19]
    s_add_u32 s27, s27, s3
    ds_read_b64_tr_b16 a[192:193], v232 offset:16384
    v_mfma_f32_16x16x32_bf16 v[20:23], v[176:179], a[4:7], v[20:23]
    s_mul_i32 s24, s3, 12288
    s_add_u32 m0, s24, 122880
    s_nop 0
    buffer_load_dwordx4 v5, s[44:47], s31 offen lds
    v_mfma_f32_16x16x32_bf16 v[24:27], v[176:179], a[8:11], v[24:27]
    ds_read_b64_tr_b16 a[194:195], v232 offset:16896
    v_mfma_f32_16x16x32_bf16 v[28:31], v[176:179], a[12:15], v[28:31]
    ds_read_b64_tr_b16 a[196:197], v233 offset:16384
    v_mfma_f32_16x16x32_bf16 v[32:35], v[180:183], a[0:3], v[32:35]
    ds_read_b64_tr_b16 a[198:199], v233 offset:16896
    v_mfma_f32_16x16x32_bf16 v[36:39], v[180:183], a[4:7], v[36:39]
    buffer_load_dwordx4 v5, s[44:47], s34 offen offset:1024 lds
    v_mfma_f32_16x16x32_bf16 v[40:43], v[180:183], a[8:11], v[40:43]
    ds_read_b64_tr_b16 a[200:201], v234 offset:16384
    v_mfma_f32_16x16x32_bf16 v[44:47], v[180:183], a[12:15], v[44:47]
    ds_read_b64_tr_b16 a[202:203], v234 offset:16896
    v_mfma_f32_16x16x32_bf16 v[48:51], v[184:187], a[0:3], v[48:51]
    ds_read_b64_tr_b16 a[204:205], v235 offset:16384
    v_mfma_f32_16x16x32_bf16 v[52:55], v[184:187], a[4:7], v[52:55]
    ds_read_b64_tr_b16 a[206:207], v235 offset:16896
    buffer_load_dwordx2 v[82:83], v6, s[52:55], s38 offen sc1
    v_mfma_f32_16x16x32_bf16 v[56:59], v[184:187], a[8:11], v[56:59]
    v_mfma_f32_16x16x32_bf16 v[60:63], v[184:187], a[12:15], v[60:63]
    v_mfma_f32_16x16x32_bf16 v[64:67], v[188:191], a[0:3], v[64:67]
    v_mfma_f32_16x16x32_bf16 v[68:71], v[188:191], a[4:7], v[68:71]
    v_mfma_f32_16x16x32_bf16 v[72:75], v[188:191], a[8:11], v[72:75]
    buffer_load_dwordx4 a[56:59], v246, s[52:55], s74 offen sc1
    v_mfma_f32_16x16x32_bf16 v[76:79], v[188:191], a[12:15], v[76:79]
    s_waitcnt vmcnt(11) lgkmcnt(15)
    v_mfma_f32_16x16x32_bf16 v[16:19], a[240:243], a[16:19], v[16:19]
    v_mfma_f32_16x16x32_bf16 v[20:23], a[240:243], a[20:23], v[20:23]
    buffer_load_dwordx4 a[72:75], v246, s[52:55], s75 offen sc1
    v_mfma_f32_16x16x32_bf16 v[24:27], a[240:243], a[24:27], v[24:27]
    v_mfma_f32_16x16x32_bf16 v[28:31], a[240:243], a[28:31], v[28:31]
    v_mfma_f32_16x16x32_bf16 v[32:35], a[244:247], a[16:19], v[32:35]
    v_mfma_f32_16x16x32_bf16 v[36:39], a[244:247], a[20:23], v[36:39]
    buffer_load_dwordx4 a[88:91], v246, s[52:55], s76 offen sc1
    v_mfma_f32_16x16x32_bf16 v[40:43], a[244:247], a[24:27], v[40:43]
    v_mfma_f32_16x16x32_bf16 v[44:47], a[244:247], a[28:31], v[44:47]
    v_mfma_f32_16x16x32_bf16 v[48:51], a[248:251], a[16:19], v[48:51]
    buffer_load_dwordx4 a[104:107], v246, s[52:55], s77 offen sc1
    v_mfma_f32_16x16x32_bf16 v[52:55], a[248:251], a[20:23], v[52:55]
    v_mfma_f32_16x16x32_bf16 v[56:59], a[248:251], a[24:27], v[56:59]
    v_mfma_f32_16x16x32_bf16 v[60:63], a[248:251], a[28:31], v[60:63]
    buffer_load_dwordx4 a[120:123], v246, s[52:55], s78 offen sc1
    v_mfma_f32_16x16x32_bf16 v[64:67], a[252:255], a[16:19], v[64:67]
    v_mfma_f32_16x16x32_bf16 v[68:71], a[252:255], a[20:23], v[68:71]
    v_mfma_f32_16x16x32_bf16 v[72:75], a[252:255], a[24:27], v[72:75]
    buffer_load_dwordx4 a[44:47], v247, s[52:55], s73 offen sc1
    v_mfma_f32_16x16x32_bf16 v[76:79], a[252:255], a[28:31], v[76:79]
    s_waitcnt vmcnt(15)
    v_mfma_f32_16x16x32_bf16 v[20:23], a[224:227], a[36:39], v[20:23]
    v_lshrrev_b32 v14, 2, v1
    v_lshlrev_b32 v14, 7, v14
    s_lshl_b32 s93, s9, 1
    s_lshr_b32 s24, s8, 4
    s_add_u32 s93, s93, s24
    s_lshl_b32 s93, s93, 2
    s_add_u32 s93, s93, s3
    s_lshl_b32 s93, s93, 11
    s_add_u32 s93, s93, 12681216
    buffer_load_dwordx2 v[248:249], v14, s[52:55], s93 offen sc1
    v_mfma_f32_16x16x32_bf16 v[36:39], a[228:231], a[36:39], v[36:39]
    v_mfma_f32_16x16x32_bf16 v[52:55], a[232:235], a[36:39], v[52:55]
    buffer_load_dwordx4 a[60:63], v247, s[52:55], s74 offen sc1
    v_mfma_f32_16x16x32_bf16 v[68:71], a[236:239], a[36:39], v[68:71]
    s_waitcnt vmcnt(16)
    v_mfma_f32_16x16x32_bf16 v[20:23], a[128:131], a[52:55], v[20:23]
    v_mfma_f32_16x16x32_bf16 v[36:39], a[132:135], a[52:55], v[36:39]
    v_mfma_f32_16x16x32_bf16 v[52:55], a[136:139], a[52:55], v[52:55]
    v_mfma_f32_16x16x32_bf16 v[68:71], a[140:143], a[52:55], v[68:71]
    buffer_load_dwordx4 a[76:79], v247, s[52:55], s75 offen sc1
    s_waitcnt vmcnt(16)
    v_mfma_f32_16x16x32_bf16 v[20:23], a[144:147], a[68:71], v[20:23]
    v_mfma_f32_16x16x32_bf16 v[36:39], a[148:151], a[68:71], v[36:39]
    v_mfma_f32_16x16x32_bf16 v[52:55], a[152:155], a[68:71], v[52:55]
    v_mfma_f32_16x16x32_bf16 v[68:71], a[156:159], a[68:71], v[68:71]
    buffer_load_dwordx4 a[92:95], v247, s[52:55], s76 offen sc1
    s_waitcnt vmcnt(11)
    v_mfma_f32_16x16x32_bf16 v[20:23], a[160:163], a[84:87], v[20:23]
    ds_read_b64 v[84:85], v195 offset:0
    v_mfma_f32_16x16x32_bf16 v[36:39], a[164:167], a[84:87], v[36:39]
    ds_read_b64 v[86:87], v195 offset:32
    v_mfma_f32_16x16x32_bf16 v[52:55], a[168:171], a[84:87], v[52:55]
    ds_read_b64 v[88:89], v195 offset:64
    v_mfma_f32_16x16x32_bf16 v[68:71], a[172:175], a[84:87], v[68:71]
    ds_read_b64 v[90:91], v195 offset:96
    s_waitcnt lgkmcnt(12)
    v_mfma_f32_16x16x32_bf16 v[20:23], a[176:179], a[100:103], v[20:23]
    buffer_load_dwordx4 a[108:111], v247, s[52:55], s77 offen sc1
    v_mfma_f32_16x16x32_bf16 v[36:39], a[180:183], a[100:103], v[36:39]
    s_waitcnt vmcnt(11)
    v_cmp_ne_u32 vcc, s88, v83
    s_cbranch_vccnz L_gp_45
L_gd_46:
    v_mfma_f32_16x16x32_bf16 v[52:55], a[184:187], a[100:103], v[52:55]
    v_sub_f32 v80, 1.0, v82
    v_cvt_pk_bf16_f32 v80, v80, v80
    v_mfma_f32_16x16x32_bf16 v[68:71], a[188:191], a[100:103], v[68:71]
    buffer_load_dwordx4 a[124:127], v247, s[52:55], s78 offen sc1
    v_lshlrev_b32 v80, 16, v80
    s_waitcnt lgkmcnt(4)
    v_mfma_f32_16x16x32_bf16 v[20:23], a[192:195], a[116:119], v[20:23]
    v_mfma_f32_16x16x32_bf16 v[36:39], a[196:199], a[116:119], v[36:39]
    v_mfma_f32_16x16x32_bf16 v[52:55], a[200:203], a[116:119], v[52:55]
    s_waitcnt lgkmcnt(0)
    buffer_load_dwordx4 a[32:35], v244, s[52:55], s73 offen sc1
    v_lshlrev_b32 v100, 16, v84
    v_mfma_f32_16x16x32_bf16 v[68:71], a[204:207], a[116:119], v[68:71]
    v_and_b32 v101, 0xffff0000, v84
    v_lshlrev_b32 v102, 16, v85
    v_mfma_f32_16x16x32_bf16 v[24:27], a[224:227], a[40:43], v[24:27]
    v_and_b32 v103, 0xffff0000, v85
    v_mul_f32 v100, v100, v82
    v_mfma_f32_16x16x32_bf16 v[40:43], a[228:231], a[40:43], v[40:43]
    buffer_load_dwordx4 a[48:51], v244, s[52:55], s74 offen sc1
    v_mul_f32 v101, v101, v82
    s_waitcnt vmcnt(13)
    v_mfma_f32_16x16x32_bf16 v[24:27], a[128:131], a[56:59], v[24:27]
    ds_write_b128 v192, v[20:23] offset:0
    v_mfma_f32_16x16x32_bf16 v[40:43], a[132:135], a[56:59], v[40:43]
    buffer_load_dwordx4 a[64:67], v244, s[52:55], s75 offen sc1
    v_mul_f32 v102, v102, v82
    s_waitcnt vmcnt(13)
    v_mfma_f32_16x16x32_bf16 v[24:27], a[144:147], a[72:75], v[24:27]
    v_mul_f32 v103, v103, v82
    v_lshlrev_b32 v104, 16, v86
    v_mfma_f32_16x16x32_bf16 v[40:43], a[148:151], a[72:75], v[40:43]
    ds_write_b128 v192, v[36:39] offset:1024
    buffer_load_dwordx4 a[80:83], v244, s[52:55], s76 offen sc1
    s_waitcnt vmcnt(13)
    v_mfma_f32_16x16x32_bf16 v[24:27], a[160:163], a[88:91], v[24:27]
    v_and_b32 v105, 0xffff0000, v86
    v_lshlrev_b32 v106, 16, v87
    v_mfma_f32_16x16x32_bf16 v[40:43], a[164:167], a[88:91], v[40:43]
    v_and_b32 v107, 0xffff0000, v87
    v_mul_f32 v104, v104, v82
    s_waitcnt vmcnt(12)
    v_mfma_f32_16x16x32_bf16 v[24:27], a[176:179], a[104:107], v[24:27]
    buffer_load_dwordx4 a[96:99], v244, s[52:55], s77 offen sc1
    v_mul_f32 v105, v105, v82
    v_mfma_f32_16x16x32_bf16 v[40:43], a[180:183], a[104:107], v[40:43]
    ds_write_b128 v192, v[52:55] offset:2048
    s_waitcnt vmcnt(12)
    v_mfma_f32_16x16x32_bf16 v[24:27], a[192:195], a[120:123], v[24:27]
    v_mul_f32 v106, v106, v82
    v_mul_f32 v107, v107, v82
    v_mfma_f32_16x16x32_bf16 v[40:43], a[196:199], a[120:123], v[40:43]
    buffer_load_dwordx4 a[112:115], v244, s[52:55], s78 offen sc1
    v_lshlrev_b32 v108, 16, v88
    v_mfma_f32_16x16x32_bf16 v[56:59], a[232:235], a[40:43], v[56:59]
    s_waitcnt vmcnt(11)
    v_cmp_ne_u64 vcc, s[42:43], v[248:249]
    s_cbranch_vccnz L_pl_47
L_pd_48:
    v_mfma_f32_16x16x32_bf16 v[72:75], a[236:239], a[40:43], v[72:75]
    ds_write_b128 v192, v[68:71] offset:3072
    v_mfma_f32_16x16x32_bf16 v[56:59], a[136:139], a[56:59], v[56:59]
    s_add_u32 m0, s22, 100352
    s_nop 0
    buffer_load_dwordx4 v7, s[52:55], s19 offen sc1 lds
    v_mfma_f32_16x16x32_bf16 v[72:75], a[140:143], a[56:59], v[72:75]
    v_and_b32 v109, 0xffff0000, v88
    v_lshlrev_b32 v110, 16, v89
    v_mfma_f32_16x16x32_bf16 v[56:59], a[152:155], a[72:75], v[56:59]
    ds_write_b128 v193, v[24:27] offset:0
    v_mfma_f32_16x16x32_bf16 v[72:75], a[156:159], a[72:75], v[72:75]
    buffer_load_dwordx4 v7, s[52:55], s21 offen offset:1024 sc1 lds
    v_and_b32 v111, 0xffff0000, v89
    v_mfma_f32_16x16x32_bf16 v[56:59], a[168:171], a[88:91], v[56:59]
    v_mul_f32 v108, v108, v82
    v_mul_f32 v109, v109, v82
    v_mfma_f32_16x16x32_bf16 v[72:75], a[172:175], a[88:91], v[72:75]
    ds_write_b128 v193, v[40:43] offset:1024
    v_mfma_f32_16x16x32_bf16 v[56:59], a[184:187], a[104:107], v[56:59]
    v_mul_f32 v110, v110, v82
    v_mul_f32 v111, v111, v82
    v_mfma_f32_16x16x32_bf16 v[72:75], a[188:191], a[104:107], v[72:75]
    v_lshlrev_b32 v112, 16, v90
    v_and_b32 v113, 0xffff0000, v90
    v_mfma_f32_16x16x32_bf16 v[56:59], a[200:203], a[120:123], v[56:59]
    v_lshlrev_b32 v114, 16, v91
    v_and_b32 v115, 0xffff0000, v91
    v_mfma_f32_16x16x32_bf16 v[72:75], a[204:207], a[120:123], v[72:75]
    v_mul_f32 v112, v112, v82
    v_mul_f32 v113, v113, v82
    v_mfma_f32_16x16x32_bf16 v[28:31], a[224:227], a[44:47], v[28:31]
    v_mul_f32 v114, v114, v82
    v_mul_f32 v115, v115, v82
    v_mfma_f32_16x16x32_bf16 v[44:47], a[228:231], a[44:47], v[44:47]
    ds_write_b128 v193, v[56:59] offset:2048
    s_waitcnt vmcnt(12)
    v_mfma_f32_16x16x32_bf16 v[28:31], a[128:131], a[60:63], v[28:31]
    v_mfma_f32_16x16x32_bf16 v[44:47], a[132:135], a[60:63], v[44:47]
    s_waitcnt vmcnt(11)
    v_mfma_f32_16x16x32_bf16 v[28:31], a[144:147], a[76:79], v[28:31]
    ds_write_b128 v193, v[72:75] offset:3072
    v_mfma_f32_16x16x32_bf16 v[44:47], a[148:151], a[76:79], v[44:47]
    s_waitcnt vmcnt(10)
    v_mfma_f32_16x16x32_bf16 v[28:31], a[160:163], a[92:95], v[28:31]
    v_mfma_f32_16x16x32_bf16 v[44:47], a[164:167], a[92:95], v[44:47]
    s_waitcnt vmcnt(9)
    v_mfma_f32_16x16x32_bf16 v[28:31], a[176:179], a[108:111], v[28:31]
    v_mfma_f32_16x16x32_bf16 v[44:47], a[180:183], a[108:111], v[44:47]
    s_waitcnt vmcnt(8)
    v_mfma_f32_16x16x32_bf16 v[28:31], a[192:195], a[124:127], v[28:31]
    v_mfma_f32_16x16x32_bf16 v[44:47], a[196:199], a[124:127], v[44:47]
    v_mfma_f32_16x16x32_bf16 v[60:63], a[232:235], a[44:47], v[60:63]
    v_mfma_f32_16x16x32_bf16 v[76:79], a[236:239], a[44:47], v[76:79]
    v_mfma_f32_16x16x32_bf16 v[60:63], a[136:139], a[60:63], v[60:63]
    s_waitcnt lgkmcnt(0)
    s_barrier
    ds_read_b128 v[128:131], v197 offset:0
    v_mfma_f32_16x16x32_bf16 v[76:79], a[140:143], a[60:63], v[76:79]
    ds_read_b128 v[144:147], v197 offset:4096
    v_mfma_f32_16x16x32_bf16 v[60:63], a[152:155], a[76:79], v[60:63]
    ds_read_b128 v[132:135], v197 offset:1024
    v_mfma_f32_16x16x32_bf16 v[76:79], a[156:159], a[76:79], v[76:79]
    ds_read_b128 v[148:151], v197 offset:5120
    v_mfma_f32_16x16x32_bf16 v[60:63], a[168:171], a[92:95], v[60:63]
    ds_read_b128 v[136:139], v197 offset:2048
    v_mfma_f32_16x16x32_bf16 v[76:79], a[172:175], a[92:95], v[76:79]
    ds_read_b128 v[152:155], v197 offset:6144
    v_mfma_f32_16x16x32_bf16 v[60:63], a[184:187], a[108:111], v[60:63]
    ds_read_b128 v[140:143], v197 offset:3072
    v_mfma_f32_16x16x32_bf16 v[76:79], a[188:191], a[108:111], v[76:79]
    ds_read_b128 v[156:159], v197 offset:7168
    v_mfma_f32_16x16x32_bf16 v[60:63], a[200:203], a[124:127], v[60:63]
    ds_write_b128 v194, v[28:31] offset:0
    v_mfma_f32_16x16x32_bf16 v[76:79], a[204:207], a[124:127], v[76:79]
    s_waitcnt lgkmcnt(7)
    v_add_f32 v128, v128, v144
    v_add_f32 v129, v129, v145
    s_waitcnt vmcnt(7)
    v_mfma_f32_16x16x32_bf16 v[16:19], a[224:227], a[32:35], v[16:19]
    v_add_f32 v130, v130, v146
    v_add_f32 v131, v131, v147
    v_mfma_f32_16x16x32_bf16 v[32:35], a[228:231], a[32:35], v[32:35]
    s_waitcnt lgkmcnt(5)
    ds_write_b128 v194, v[44:47] offset:1024
    s_waitcnt vmcnt(6)
    v_mfma_f32_16x16x32_bf16 v[16:19], a[128:131], a[48:51], v[16:19]
    v_add_f32 v132, v132, v148
    v_add_f32 v133, v133, v149
    v_mfma_f32_16x16x32_bf16 v[32:35], a[132:135], a[48:51], v[32:35]
    v_add_f32 v134, v134, v150
    v_add_f32 v135, v135, v151
    s_waitcnt vmcnt(5)
    v_mfma_f32_16x16x32_bf16 v[16:19], a[144:147], a[64:67], v[16:19]
    s_waitcnt lgkmcnt(4)
    ds_write_b128 v194, v[60:63] offset:2048
    v_mfma_f32_16x16x32_bf16 v[32:35], a[148:151], a[64:67], v[32:35]
    v_add_f32 v136, v136, v152
    v_add_f32 v137, v137, v153
    s_waitcnt vmcnt(4)
    v_mfma_f32_16x16x32_bf16 v[16:19], a[160:163], a[80:83], v[16:19]
    v_add_f32 v138, v138, v154
    v_add_f32 v139, v139, v155
    v_mfma_f32_16x16x32_bf16 v[32:35], a[164:167], a[80:83], v[32:35]
    s_waitcnt lgkmcnt(3)
    ds_write_b128 v194, v[76:79] offset:3072
    s_waitcnt vmcnt(3)
    v_mfma_f32_16x16x32_bf16 v[16:19], a[176:179], a[96:99], v[16:19]
    v_add_f32 v140, v140, v156
    v_add_f32 v141, v141, v157
    v_mfma_f32_16x16x32_bf16 v[32:35], a[180:183], a[96:99], v[32:35]
    v_add_f32 v142, v142, v158
    v_add_f32 v143, v143, v159
    s_waitcnt vmcnt(2)
    v_mfma_f32_16x16x32_bf16 v[16:19], a[192:195], a[112:115], v[16:19]
    v_mfma_f32_16x16x32_bf16 v[32:35], a[196:199], a[112:115], v[32:35]
    v_mfma_f32_16x16x32_bf16 v[48:51], a[232:235], a[32:35], v[48:51]
    v_mfma_f32_16x16x32_bf16 v[64:67], a[236:239], a[32:35], v[64:67]
    v_add_f32 v16, v16, v128
    v_add_f32 v17, v17, v129
    v_mfma_f32_16x16x32_bf16 v[48:51], a[136:139], a[48:51], v[48:51]
    v_add_f32 v18, v18, v130
    v_add_f32 v19, v19, v131
    v_mfma_f32_16x16x32_bf16 v[64:67], a[140:143], a[48:51], v[64:67]
    v_add_f32 v32, v32, v132
    v_add_f32 v33, v33, v133
    v_mfma_f32_16x16x32_bf16 v[48:51], a[152:155], a[64:67], v[48:51]
    s_waitcnt vmcnt(0) lgkmcnt(0)
    s_barrier
    ds_read_b64_tr_b16 v[92:93], v196 offset:0
    v_mfma_f32_16x16x32_bf16 v[64:67], a[156:159], a[64:67], v[64:67]
    ds_read_b128 v[160:163], v197 offset:8192
    v_add_f32 v34, v34, v134
    v_mfma_f32_16x16x32_bf16 v[48:51], a[168:171], a[80:83], v[48:51]
    ds_read_b64_tr_b16 v[94:95], v196 offset:4096
    v_add_f32 v35, v35, v135
    v_mfma_f32_16x16x32_bf16 v[64:67], a[172:175], a[80:83], v[64:67]
    ds_read_b128 v[164:167], v197 offset:9216
    v_mfma_f32_16x16x32_bf16 v[48:51], a[184:187], a[96:99], v[48:51]
    ds_read_b64_tr_b16 v[96:97], v196 offset:8192
    v_mfma_f32_16x16x32_bf16 v[64:67], a[188:191], a[96:99], v[64:67]
    ds_read_b128 v[168:171], v197 offset:10240
    v_mfma_f32_16x16x32_bf16 v[48:51], a[200:203], a[112:115], v[48:51]
    ds_read_b64_tr_b16 v[98:99], v196 offset:12288
    v_mfma_f32_16x16x32_bf16 v[64:67], a[204:207], a[112:115], v[64:67]
    ds_read_b128 v[172:175], v197 offset:11264
    s_cmp_eq_u32 s27, 0
    s_cbranch_scc1 L_wb_49
L_wd_50:
    s_nop 3
    v_pk_add_f32 v[48:49], v[48:49], v[136:137]
    v_pk_add_f32 v[50:51], v[50:51], v[138:139]
    v_pk_add_f32 v[64:65], v[64:65], v[140:141]
    v_pk_add_f32 v[66:67], v[66:67], v[142:143]
    s_waitcnt lgkmcnt(6)
    v_lshlrev_b32 v224, 16, v92
    v_and_b32 v225, 0xffff0000, v92
    v_lshlrev_b32 v226, 16, v93
    v_and_b32 v227, 0xffff0000, v93
    v_pk_mul_f32 v[100:101], v[100:101], v[224:225]
    v_pk_mul_f32 v[102:103], v[102:103], v[226:227]
    v_pk_add_f32 v[16:17], v[16:17], v[160:161]
    v_pk_add_f32 v[18:19], v[18:19], v[162:163]
    v_pk_fma_f32 v[100:101], v[16:17], v[80:81], v[100:101] op_sel:[0,0,0] op_sel_hi:[1,0,1]
    v_pk_fma_f32 v[102:103], v[18:19], v[80:81], v[102:103] op_sel:[0,0,0] op_sel_hi:[1,0,1]
    v_cvt_pk_bf16_f32 v116, v100, v101
    v_cvt_pk_bf16_f32 v117, v102, v103
    s_waitcnt lgkmcnt(4)
    v_lshlrev_b32 v224, 16, v94
    v_and_b32 v225, 0xffff0000, v94
    v_lshlrev_b32 v226, 16, v95
    v_and_b32 v227, 0xffff0000, v95
    v_pk_mul_f32 v[104:105], v[104:105], v[224:225]
    v_pk_mul_f32 v[106:107], v[106:107], v[226:227]
    v_pk_add_f32 v[32:33], v[32:33], v[164:165]
    v_pk_add_f32 v[34:35], v[34:35], v[166:167]
    v_pk_fma_f32 v[104:105], v[32:33], v[80:81], v[104:105] op_sel:[0,0,0] op_sel_hi:[1,0,1]
    v_pk_fma_f32 v[106:107], v[34:35], v[80:81], v[106:107] op_sel:[0,0,0] op_sel_hi:[1,0,1]
    v_cvt_pk_bf16_f32 v118, v104, v105
    v_cvt_pk_bf16_f32 v119, v106, v107
    s_nop 1
    v_permlane16_swap_b32 v116, v118
    v_permlane16_swap_b32 v117, v119
    buffer_store_dwordx4 v[116:119], v198, s[68:71], s31 offen offset:0 sc1
    s_waitcnt lgkmcnt(2)
    v_lshlrev_b32 v224, 16, v96
    v_and_b32 v225, 0xffff0000, v96
    v_lshlrev_b32 v226, 16, v97
    v_and_b32 v227, 0xffff0000, v97
    v_pk_mul_f32 v[108:109], v[108:109], v[224:225]
    v_pk_mul_f32 v[110:111], v[110:111], v[226:227]
    v_pk_add_f32 v[48:49], v[48:49], v[168:169]
    v_pk_add_f32 v[50:51], v[50:51], v[170:171]
    v_pk_fma_f32 v[108:109], v[48:49], v[80:81], v[108:109] op_sel:[0,0,0] op_sel_hi:[1,0,1]
    v_pk_fma_f32 v[110:111], v[50:51], v[80:81], v[110:111] op_sel:[0,0,0] op_sel_hi:[1,0,1]
    v_cvt_pk_bf16_f32 v120, v108, v109
    v_cvt_pk_bf16_f32 v121, v110, v111
    s_waitcnt lgkmcnt(0)
    v_lshlrev_b32 v224, 16, v98
    v_and_b32 v225, 0xffff0000, v98
    v_lshlrev_b32 v226, 16, v99
    v_and_b32 v227, 0xffff0000, v99
    v_pk_mul_f32 v[112:113], v[112:113], v[224:225]
    v_pk_mul_f32 v[114:115], v[114:115], v[226:227]
    v_pk_add_f32 v[64:65], v[64:65], v[172:173]
    v_pk_add_f32 v[66:67], v[66:67], v[174:175]
    v_pk_fma_f32 v[112:113], v[64:65], v[80:81], v[112:113] op_sel:[0,0,0] op_sel_hi:[1,0,1]
    v_pk_fma_f32 v[114:115], v[66:67], v[80:81], v[114:115] op_sel:[0,0,0] op_sel_hi:[1,0,1]
    v_cvt_pk_bf16_f32 v122, v112, v113
    v_cvt_pk_bf16_f32 v123, v114, v115
    s_nop 1
    v_permlane16_swap_b32 v120, v122
    v_permlane16_swap_b32 v121, v123
    buffer_store_dwordx4 v[120:123], v198, s[68:71], s31 offen offset:64 sc1
    s_endpgm
L_codeend:
L_np_3:
    s_mov_b32 s93, 0
L_np_3_l:
    s_sleep 1
    buffer_load_dwordx2 v[248:249], v14, s[56:59], 0 offen sc1
    s_waitcnt vmcnt(0)
    v_readlane_b32 s89, v249, s4
    v_readlane_b32 s43, v249, s9
    s_add_u32 s93, s93, 1
    s_cmp_lt_u32 s93, 16384
    s_cbranch_scc0 L_nd_4
    s_min_u32 s92, s89, s43
    s_cmp_eq_u32 s92, 0
    s_cbranch_scc1 L_np_3_l
    s_branch L_nd_4
L_mc_6:
    s_mov_b32 s24, 0
L_mc_6_l:
    s_mov_b32 s30, 0
    s_cmp_eq_u32 vcc_lo, -1
    s_cbranch_scc1 L_md_7
    s_cmp_eq_u32 vcc_hi, -1
    s_cbranch_scc1 L_md_7
    v_and_b32 v221, 0xf0ffffff, v221
    v_cmp_eq_u64 vcc, s[88:89], v[220:221]
    s_mov_b32 s30, 1
    s_cmp_eq_u32 vcc_hi, -1
    s_cbranch_scc1 L_md_7
    s_add_u32 s24, s24, 1
    s_cmp_lt_u32 s24, 16384
    s_cbranch_scc0 L_md_7
    s_lshl_b32 s92, s4, 9
    s_add_u32 s92, s92, 12648448
    s_cmp_lg_u32 s24, 64
    s_cbranch_scc1 L_mc_6_n
    s_lshl_b32 s30, s5, 3
    s_add_u32 s30, s30, s92
    s_mov_b64 exec, 1
    buffer_store_dwordx2 v[12:13], v10, s[52:55], s30 offen offset:256 sc1
    s_mov_b64 exec, -1
L_mc_6_n:
    s_sleep 1
    buffer_load_dwordx2 v[220:221], v218, s[52:55], s92 offen sc1
    s_waitcnt vmcnt(0)
    v_cmp_eq_u64 vcc, s[90:91], v[220:221]
    s_branch L_mc_6_l
L_pl_8:
    s_mov_b32 s92, 0
L_pl_8_l:
    buffer_load_dwordx2 v[248:249], v14, s[52:55], s93 offen sc1
    s_waitcnt vmcnt(0)
    v_cmp_ne_u64 vcc, s[88:89], v[248:249]
    s_add_u32 s92, s92, 1
    s_cmp_lt_u32 s92, 16384
    s_cbranch_scc0 L_pd_9
    s_cbranch_vccnz L_pl_8_l
    s_branch L_pd_9
L_fs_10:
    buffer_store_dwordx4 v[16:19], v219, s[52:55], s12 offen sc1
    buffer_store_dwordx4 v[32:35], v219, s[52:55], s13 offen sc1
    buffer_store_dwordx4 v[48:51], v219, s[52:55], s14 offen sc1
    buffer_store_dwordx4 v[64:67], v219, s[52:55], s15 offen sc1
    s_waitcnt vmcnt(0)
    s_mov_b64 exec, 1
    buffer_store_dwordx2 v[12:13], v10, s[52:55], s92 offen sc1
    s_mov_b64 exec, -1
    s_branch L_fd_11
L_fs_12:
    buffer_store_dwordx4 v[24:27], v15, s[52:55], s12 offen sc1
    buffer_store_dwordx4 v[40:43], v15, s[52:55], s13 offen sc1
    buffer_store_dwordx4 v[56:59], v15, s[52:55], s14 offen sc1
    buffer_store_dwordx4 v[72:75], v15, s[52:55], s15 offen sc1
    s_waitcnt vmcnt(0)
    s_mov_b64 exec, 1
    buffer_store_dwordx2 v[12:13], v10, s[52:55], s92 offen sc1
    s_mov_b64 exec, -1
    s_branch L_fd_13
L_pl_14:
    s_mov_b32 s92, 0
L_pl_14_l:
    buffer_load_dwordx2 v[248:249], v14, s[52:55], s93 offen sc1
    s_waitcnt vmcnt(0)
    v_cmp_ne_u64 vcc, s[88:89], v[248:249]
    s_add_u32 s92, s92, 1
    s_cmp_lt_u32 s92, 16384
    s_cbranch_scc0 L_pd_15
    s_cbranch_vccnz L_pl_14_l
    s_branch L_pd_15
L_e1_16:
    ds_write_b128 v8, v[192:195] offset:0
    ds_write_b128 v8, v[196:199] offset:1024
    ds_write_b128 v8, v[200:203] offset:2048
    ds_write_b128 v8, v[204:207] offset:3072
    s_branch L_ej_17
L_e1_18:
    v_pk_fma_f32 v[48:49], v[32:33], s[24:25], v[208:209] op_sel_hi:[1,0,1]
    v_pk_fma_f32 v[50:51], v[34:35], s[24:25], v[210:211] op_sel_hi:[1,0,1]
    v_pk_fma_f32 v[52:53], v[36:37], s[24:25], v[212:213] op_sel_hi:[1,0,1]
    v_pk_fma_f32 v[54:55], v[38:39], s[24:25], v[214:215] op_sel_hi:[1,0,1]
    v_pk_fma_f32 v[56:57], v[40:41], s[24:25], v[216:217] op_sel_hi:[1,0,1]
    v_pk_fma_f32 v[58:59], v[42:43], s[24:25], v[218:219] op_sel_hi:[1,0,1]
    v_pk_fma_f32 v[60:61], v[44:45], s[24:25], v[220:221] op_sel_hi:[1,0,1]
    v_pk_fma_f32 v[62:63], v[46:47], s[24:25], v[222:223] op_sel_hi:[1,0,1]
    s_branch L_ej_19
L_pl_20:
    s_mov_b32 s92, 0
L_pl_20_l:
    buffer_load_dwordx2 v[248:249], v14, s[52:55], s93 offen sc1
    s_waitcnt vmcnt(0)
    v_cmp_ne_u64 vcc, s[88:89], v[248:249]
    s_add_u32 s92, s92, 1
    s_cmp_lt_u32 s92, 16384
    s_cbranch_scc0 L_pd_21
    s_cbranch_vccnz L_pl_20_l
    s_branch L_pd_21
L_gp_22:
    s_mov_b32 s92, 0
L_gp_22_l:
    buffer_load_dwordx2 v[82:83], v6, s[52:55], s38 offen sc1
    s_waitcnt vmcnt(0)
    v_cmp_ne_u32 vcc, s88, v83
    s_add_u32 s92, s92, 1
    s_cmp_lt_u32 s92, 16384
    s_cbranch_scc0 L_gd_23
    s_cbranch_vccnz L_gp_22_l
    s_branch L_gd_23
L_pl_24:
    s_mov_b32 s92, 0
L_pl_24_l:
    s_and_b32 s24, s9, 7
    s_lshl_b32 s24, s24, 3
    buffer_load_dwordx2 v[224:225], v10, s[56:59], s24 offen sc1
    buffer_load_dwordx2 v[248:249], v14, s[52:55], s93 offen sc1
    s_waitcnt vmcnt(0)
    v_readfirstlane_b32 s42, v224
    v_readfirstlane_b32 s43, v225
    s_nop 3
    v_cmp_ne_u64 vcc, s[42:43], v[248:249]
    s_add_u32 s92, s92, 1
    s_cmp_lt_u32 s92, 16384
    s_cbranch_scc0 L_pd_25
    s_cbranch_vccnz L_pl_24_l
    s_branch L_pd_25
L_wb_26:
    buffer_wbl2 sc1
    s_branch L_wd_27
L_np_28:
    s_mov_b32 s93, 0
L_np_28_l:
    s_sleep 1
    buffer_load_dwordx2 v[248:249], v14, s[56:59], 0 offen sc1
    s_waitcnt vmcnt(0)
    v_readlane_b32 s89, v249, s4
    v_readlane_b32 s43, v249, s9
    s_add_u32 s93, s93, 1
    s_cmp_lt_u32 s93, 16384
    s_cbranch_scc0 L_nd_29
    s_min_u32 s92, s89, s43
    s_cmp_eq_u32 s92, 0
    s_cbranch_scc1 L_np_28_l
    s_branch L_nd_29
L_mc_31:
    s_mov_b32 s24, 0
L_mc_31_l:
    s_mov_b32 s30, 0
    s_cmp_eq_u32 vcc_lo, -1
    s_cbranch_scc1 L_md_32
    s_cmp_eq_u32 vcc_hi, -1
    s_cbranch_scc1 L_md_32
    v_and_b32 v249, 0xf0ffffff, v249
    v_cmp_eq_u64 vcc, s[88:89], v[248:249]
    s_mov_b32 s30, 1
    s_cmp_eq_u32 vcc_hi, -1
    s_cbranch_scc1 L_md_32
    s_add_u32 s24, s24, 1
    s_cmp_lt_u32 s24, 16384
    s_cbranch_scc0 L_md_32
    s_lshl_b32 s92, s4, 9
    s_add_u32 s92, s92, 12648448
    s_cmp_lg_u32 s24, 64
    s_cbranch_scc1 L_mc_31_n
    s_lshl_b32 s30, s5, 3
    s_add_u32 s30, s30, s92
    s_mov_b64 exec, 1
    buffer_store_dwordx2 v[12:13], v10, s[52:55], s30 offen offset:256 sc1
    s_mov_b64 exec, -1
L_mc_31_n:
    s_sleep 1
    buffer_load_dwordx2 v[248:249], v14, s[52:55], s92 offen sc1
    s_waitcnt vmcnt(0)
    v_cmp_eq_u64 vcc, s[90:91], v[248:249]
    s_branch L_mc_31_l
L_fs_33:
    v_xor_b32 v251, 0, v250
    s_add_u32 s24, s11, 0
    buffer_store_dwordx4 v[24:27], v251, s[52:55], s24 offen offset:128 sc1
    v_xor_b32 v251, 16, v250
    s_add_u32 s24, s11, 32768
    buffer_store_dwordx4 v[28:31], v251, s[52:55], s24 offen offset:128 sc1
    v_xor_b32 v251, 32, v250
    s_add_u32 s24, s11, 65536
    buffer_store_dwordx4 v[32:35], v251, s[52:55], s24 offen offset:128 sc1
    v_xor_b32 v251, 48, v250
    s_add_u32 s24, s11, 98304
    buffer_store_dwordx4 v[36:39], v251, s[52:55], s24 offen offset:128 sc1
    v_xor_b32 v251, 64, v250
    s_add_u32 s24, s11, 131072
    buffer_store_dwordx4 v[40:43], v251, s[52:55], s24 offen offset:128 sc1
    v_xor_b32 v251, 80, v250
    s_add_u32 s24, s11, 163840
    buffer_store_dwordx4 v[44:47], v251, s[52:55], s24 offen offset:128 sc1
    v_xor_b32 v251, 96, v250
    s_add_u32 s24, s11, 196608
    buffer_store_dwordx4 v[48:51], v251, s[52:55], s24 offen offset:128 sc1
    v_xor_b32 v251, 112, v250
    s_add_u32 s24, s11, 229376
    buffer_store_dwordx4 v[52:55], v251, s[52:55], s24 offen offset:128 sc1
    v_xor_b32 v251, 0, v250
    s_add_u32 s24, s11, 0
    buffer_store_dwordx4 v[68:71], v251, s[52:55], s24 offen offset:0 sc1
    v_xor_b32 v251, 16, v250
    s_add_u32 s24, s11, 32768
    buffer_store_dwordx4 v[72:75], v251, s[52:55], s24 offen offset:0 sc1
    v_xor_b32 v251, 32, v250
    s_add_u32 s24, s11, 65536
    buffer_store_dwordx4 v[76:79], v251, s[52:55], s24 offen offset:0 sc1
    v_xor_b32 v251, 48, v250
    s_add_u32 s24, s11, 98304
    buffer_store_dwordx4 v[80:83], v251, s[52:55], s24 offen offset:0 sc1
    v_xor_b32 v251, 64, v250
    s_add_u32 s24, s11, 131072
    buffer_store_dwordx4 v[84:87], v251, s[52:55], s24 offen offset:0 sc1
    v_xor_b32 v251, 80, v250
    s_add_u32 s24, s11, 163840
    buffer_store_dwordx4 v[88:91], v251, s[52:55], s24 offen offset:0 sc1
    v_xor_b32 v251, 96, v250
    s_add_u32 s24, s11, 196608
    buffer_store_dwordx4 v[92:95], v251, s[52:55], s24 offen offset:0 sc1
    v_xor_b32 v251, 112, v250
    s_add_u32 s24, s11, 229376
    buffer_store_dwordx4 v[96:99], v251, s[52:55], s24 offen offset:0 sc1
    s_waitcnt vmcnt(0)
    s_mov_b64 exec, 1
    buffer_store_dwordx2 v[12:13], v10, s[52:55], s92 offen sc1
    s_mov_b64 exec, -1
    s_branch L_fd_34
L_pl_35:
    s_mov_b32 s92, 0
L_pl_35_l:
    buffer_load_dwordx2 v[248:249], v14, s[52:55], s93 offen sc1
    s_waitcnt vmcnt(0)
    v_cmp_ne_u64 vcc, s[88:89], v[248:249]
    s_add_u32 s92, s92, 1
    s_cmp_lt_u32 s92, 16384
    s_cbranch_scc0 L_pd_36
    s_cbranch_vccnz L_pl_35_l
    s_branch L_pd_36
L_pl_37:
    s_mov_b32 s92, 0
L_pl_37_l:
    buffer_load_dwordx2 v[248:249], v14, s[52:55], s93 offen sc1
    s_waitcnt vmcnt(0)
    v_cmp_ne_u64 vcc, s[88:89], v[248:249]
    s_add_u32 s92, s92, 1
    s_cmp_lt_u32 s92, 16384
    s_cbranch_scc0 L_pd_38
    s_cbranch_vccnz L_pl_37_l
    s_branch L_pd_38
L_e1_39:
    ds_write_b128 v8, v[192:195] offset:0
    ds_write_b128 v8, v[196:199] offset:1024
    ds_write_b128 v8, v[200:203] offset:2048
    ds_write_b128 v8, v[204:207] offset:3072
    s_branch L_ej_40
L_e1_41:
    v_pk_fma_f32 v[48:49], v[32:33], s[24:25], v[208:209] op_sel_hi:[1,0,1]
    v_pk_fma_f32 v[50:51], v[34:35], s[24:25], v[210:211] op_sel_hi:[1,0,1]
    v_pk_fma_f32 v[52:53], v[36:37], s[24:25], v[212:213] op_sel_hi:[1,0,1]
    v_pk_fma_f32 v[54:55], v[38:39], s[24:25], v[214:215] op_sel_hi:[1,0,1]
    v_pk_fma_f32 v[56:57], v[40:41], s[24:25], v[216:217] op_sel_hi:[1,0,1]
    v_pk_fma_f32 v[58:59], v[42:43], s[24:25], v[218:219] op_sel_hi:[1,0,1]
    v_pk_fma_f32 v[60:61], v[44:45], s[24:25], v[220:221] op_sel_hi:[1,0,1]
    v_pk_fma_f32 v[62:63], v[46:47], s[24:25], v[222:223] op_sel_hi:[1,0,1]
    s_branch L_ej_42
L_pl_43:
    s_mov_b32 s92, 0
L_pl_43_l:
    buffer_load_dwordx2 v[248:249], v14, s[52:55], s93 offen sc1
    s_waitcnt vmcnt(0)
    v_cmp_ne_u64 vcc, s[88:89], v[248:249]
    s_add_u32 s92, s92, 1
    s_cmp_lt_u32 s92, 16384
    s_cbranch_scc0 L_pd_44
    s_cbranch_vccnz L_pl_43_l
    s_branch L_pd_44
L_gp_45:
    s_mov_b32 s92, 0
L_gp_45_l:
    buffer_load_dwordx2 v[82:83], v6, s[52:55], s38 offen sc1
    s_waitcnt vmcnt(0)
    v_cmp_ne_u32 vcc, s88, v83
    s_add_u32 s92, s92, 1
    s_cmp_lt_u32 s92, 16384
    s_cbranch_scc0 L_gd_46
    s_cbranch_vccnz L_gp_45_l
    s_branch L_gd_46
L_pl_47:
    s_mov_b32 s92, 0
L_pl_47_l:
    s_and_b32 s24, s9, 7
    s_lshl_b32 s24, s24, 3
    buffer_load_dwordx2 v[224:225], v10, s[56:59], s24 offen sc1
    buffer_load_dwordx2 v[248:249], v14, s[52:55], s93 offen sc1
    s_waitcnt vmcnt(0)
    v_readfirstlane_b32 s42, v224
    v_readfirstlane_b32 s43, v225
    s_nop 3
    v_cmp_ne_u64 vcc, s[42:43], v[248:249]
    s_add_u32 s92, s92, 1
    s_cmp_lt_u32 s92, 16384
    s_cbranch_scc0 L_pd_48
    s_cbranch_vccnz L_pl_47_l
    s_branch L_pd_48
L_wb_49:
    buffer_wbl2 sc1
    s_branch L_wd_50
.section .rodata,"a"
.p2align 6
.amdhsa_kernel gated_mix__ssm_conv_h3__dense_activation_silu__prompt_kernel
  .amdhsa_next_free_vgpr 512
  .amdhsa_next_free_sgpr 102
  .amdhsa_accum_offset 256
  .amdhsa_group_segment_fixed_size 0
  .amdhsa_kernarg_size 104
  .amdhsa_user_sgpr_count 2
  .amdhsa_user_sgpr_kernarg_segment_ptr 1
  .amdhsa_system_sgpr_workgroup_id_x 1
.end_amdhsa_kernel
```
